```python
import torch

def _softmax(x, axis=-1):
    return torch.softmax(x, dim=axis)

def _gelu(x):
    return torch.nn.functional.gelu(x, approximate='tanh')

def _silu(x):
    return torch.nn.functional.silu(x)

def _sigmoid(x):
    return torch.sigmoid(x)

def _layernorm(x, axis=-1, eps=1e-05):
    m = x.mean(dim=axis, keepdim=True)
    v = x.var(dim=axis, keepdim=True, unbiased=False)
    return (x - m) / torch.sqrt(v + eps)

def _scatter_add(tgt, idx, src, axis=0):
    return tgt.clone().index_add_(axis, idx, src)

def _segment_sum(src, seg, n):
    out = torch.zeros((n,) + src.shape[1:], dtype=src.dtype)
    return out.index_add_(0, seg, src)

def _pad(x, pw):
    flat = tuple((v for pair in reversed(pw) for v in pair))
    return torch.nn.functional.pad(x, flat)
kernel_name = 'adaLN_cond__sliding_block__moe_arch_mod__prompt'

def setup_inputs():

    _w = lambda a: (lambda t: t.to(torch.bfloat16) if t.is_floating_point() else t)(torch.as_tensor(a))

    def _A_setup():
        B, S, D = (1, 2048, 512)
        return {'x': _w((lambda *s: torch.randn(*s, dtype=torch.bfloat16) * 0.05)(B, S, D)), 'wqkv': _w((lambda *s: torch.randn(*s, dtype=torch.bfloat16) * 0.05)(D, 3 * D)), 'wo': _w((lambda *s: torch.randn(*s, dtype=torch.bfloat16) * 0.2)(D, D))}
    _A_in = _A_setup()

    def _B_setup():
        B, S, D, F, C = (1, 2048, 512, 1376, 2)
        return {'x': _w((lambda *s: torch.randn(*s, dtype=torch.bfloat16) * 0.05)(B, S, D)), 'w_r': _w((lambda *s: torch.randn(*s, dtype=torch.bfloat16) * 3.2)(D)), 'w_gate': _w((lambda *s: torch.randn(*s, dtype=torch.bfloat16) * 0.1)(D, F)), 'w_up': _w((lambda *s: torch.randn(*s, dtype=torch.bfloat16) * 0.1)(D, F)), 'w_down': _w((lambda *s: torch.randn(*s, dtype=torch.bfloat16) * 0.1)(F, D))}
    _B_in = _B_setup()
    return {'A_x': _A_in['x'], 'A_wqkv': _A_in['wqkv'], 'A_wo': _A_in['wo'], 'B_x': _B_in['x'], 'B_w_r': _B_in['w_r'], 'B_w_gate': _B_in['w_gate'], 'B_w_up': _B_in['w_up'], 'B_w_down': _B_in['w_down'], 'c': _w((lambda *s: torch.randn(*s, dtype=torch.bfloat16) * 0.1)(1, 512) * 8.0), 'w_mod': _w((lambda *s: torch.randn(*s, dtype=torch.bfloat16) * 0.1)(512, 6 * 512) * 512 ** (-0.5) * 8.0)}

def reference(A_x, A_wqkv, A_wo, B_x, B_w_r, B_w_gate, B_w_up, B_w_down, c, w_mod):

    def _A_ref(x, wqkv, wo):
        B, S, D = x.shape
        H = 32
        Dh = D // H
        W = 256
        qkv = (lambda x, *d: x.permute(*d))((x @ wqkv).reshape(B, S, 3, H, Dh), 2, 0, 3, 1, 4)
        q, k, v = (qkv[0], qkv[1], qkv[2])
        scores = torch.einsum('bhqd,bhkd->bhqk', q, k) * Dh ** (-0.5)
        idx = torch.arange(S)
        mask = (idx[:, None] - idx[None, :] >= 0) & (idx[:, None] - idx[None, :] < W)
        scores = torch.where(mask[None, None], scores, -1000000000.0)
        p = _softmax(scores, axis=-1)
        o = torch.einsum('bhqk,bhkd->bhqd', p, v)
        return (lambda x, *d: x.permute(*d))(o, 0, 2, 1, 3).reshape(B, S, D) @ wo

    def _B_ref(x, w_r, w_gate, w_up, w_down):
        B, S, D = x.shape
        C = 2
        r = x @ w_r
        idx = torch.argsort(-r, axis=-1)[:, :C]
        idx_e = (lambda x, n, axis: torch.repeat_interleave(x, n, dim=axis))(idx.reshape(B, C, 1), D, axis=2)
        x_sel = (lambda x, i, axis: torch.take_along_dim(x, i, dim=axis))(x, idx_e, axis=1)
        g = _silu(x_sel @ w_gate)
        u = x_sel @ w_up
        y = g * u @ w_down
        r_sel = _sigmoid((lambda x, i, axis: torch.take_along_dim(x, i, dim=axis))(r, idx, axis=1))
        y = y * r_sel.reshape(B, C, 1)
        b_off = (torch.arange(B) * S).reshape(B, 1)
        flat_idx = (idx + b_off).reshape(B * C)
        zero = (x * 0.0).reshape(B * S, D)
        upd = _scatter_add(zero, flat_idx, y.reshape(B * C, D), axis=0)
        return x + upd.reshape(B, S, D)
    x = A_x
    mod = (_silu(c) @ w_mod).reshape(c.shape[0], 6, 1, -1)
    sa, ca, ga, sb, cb, gb = (mod[:, 0].clone(), mod[:, 1].clone(), mod[:, 2].clone(), mod[:, 3].clone(), mod[:, 4].clone(), mod[:, 5].clone())
    h = _layernorm(x, axis=-1) * (1 + ca) + sa
    x = x + ga * _A_ref(h, A_wqkv, A_wo)
    h = _layernorm(x, axis=-1) * (1 + cb) + sb
    x = x + gb * _B_ref(h, B_w_r, B_w_gate, B_w_up, B_w_down)
    return x
```

```asm
; @launch kernel=k0_kernel grid=(550,1,1) block=(256,1,1) lds=16384
; @launch kernel=k1_kernel grid=(256,1,1) block=(256,1,1) lds=105472
; @launch kernel=k2_kernel grid=(256,1,1) block=(512,1,1) lds=133120
; @launch kernel=k4_kernel grid=(214,1,1) block=(256,1,1) lds=24576
.amdgcn_target "amdgcn-amd-amdhsa--gfx950"
.text
.globl k0_kernel
.p2align 8
.type k0_kernel,@function
k0_kernel:
s_cmp_ge_u32 s2, 550
s_cbranch_scc1 K0_END
s_cmp_ge_u32 s2, 8
s_cbranch_scc1 K0_NOSELF
s_getpc_b64 s[60:61]
K0_PC0:
s_sub_u32 s60, s60, K0_PC0-k0_kernel
s_subb_u32 s61, s61, 0
v_lshlrev_b32 v150, 4, v0
v_mov_b32 v151, s61
v_add_co_u32 v150, vcc, s60, v150
s_nop 1
v_addc_co_u32 v151, vcc, 0, v151, vcc
global_load_dwordx4 v[152:155], v[150:151], off
v_add_co_u32 v150, vcc, 4096, v150
s_nop 1
v_addc_co_u32 v151, vcc, 0, v151, vcc
global_load_dwordx4 v[152:155], v[150:151], off
K0_NOSELF:
s_load_dwordx2 s[4:5], s[0:1], 96
s_cmp_ge_u32 s2, 534
s_cbranch_scc1 K0_P
s_cmp_ge_u32 s2, 448
s_cbranch_scc1 K0_D
s_cmp_ge_u32 s2, 416
s_cbranch_scc1 K0_R4
s_cmp_ge_u32 s2, 320
s_cbranch_scc1 K0_F
s_cmp_ge_u32 s2, 192
s_cbranch_scc1 K0_L
s_load_dwordx2 s[6:7], s[0:1], 72
s_load_dwordx2 s[8:9], s[0:1], 64
s_mov_b32 s20, 0xbfb8aa3b
s_and_b32 s12, s2, 3
s_lshr_b32 s13, s2, 2
v_lshrrev_b32 v1, 3, v0
s_lshl_b32 s14, s12, 7
v_add_u32 v1, s14, v1
v_lshlrev_b32 v2, 1, v1
v_mul_u32_u24 v3, 6144, v1
v_and_b32 v4, 7, v0
v_lshlrev_b32 v4, 4, v4
v_add_u32 v3, v3, v4
s_lshl_b32 s14, s13, 7
v_add_u32 v3, s14, v3
s_lshl_b32 s15, s2, 10
v_lshlrev_b32 v5, 2, v0
v_add_u32 v5, s15, v5
v_mov_b32 v6, 0
s_waitcnt lgkmcnt(0)
global_load_ushort v8, v2, s[8:9] offset:0
global_load_ushort v9, v2, s[8:9] offset:64
global_load_ushort v10, v2, s[8:9] offset:128
global_load_ushort v11, v2, s[8:9] offset:192
global_load_dwordx4 v[56:59], v3, s[6:7]
v_add_u32 v3, 196608, v3
global_load_dwordx4 v[60:63], v3, s[6:7]
v_add_u32 v3, 196608, v3
global_load_dwordx4 v[64:67], v3, s[6:7]
v_add_u32 v3, 196608, v3
global_load_dwordx4 v[68:71], v3, s[6:7]
v_mov_b32 v120, 0
v_mov_b32 v121, 0
v_mov_b32 v122, 0
v_mov_b32 v123, 0
v_mov_b32 v124, 0
v_mov_b32 v125, 0
v_mov_b32 v126, 0
v_mov_b32 v127, 0
s_waitcnt vmcnt(4)
v_lshlrev_b32 v8, 16, v8
v_mul_f32 v128, s20, v8
v_exp_f32 v128, v128
s_nop 0
v_add_f32 v128, 1.0, v128
v_rcp_f32 v128, v128
s_nop 0
v_mul_f32 v24, v8, v128
v_lshlrev_b32 v9, 16, v9
v_mul_f32 v129, s20, v9
v_exp_f32 v129, v129
s_nop 0
v_add_f32 v129, 1.0, v129
v_rcp_f32 v129, v129
s_nop 0
v_mul_f32 v26, v9, v129
v_lshlrev_b32 v10, 16, v10
v_mul_f32 v130, s20, v10
v_exp_f32 v130, v130
s_nop 0
v_add_f32 v130, 1.0, v130
v_rcp_f32 v130, v130
s_nop 0
v_mul_f32 v28, v10, v130
v_lshlrev_b32 v11, 16, v11
v_mul_f32 v131, s20, v11
v_exp_f32 v131, v131
s_nop 0
v_add_f32 v131, 1.0, v131
v_rcp_f32 v131, v131
s_nop 0
v_mul_f32 v30, v11, v131
v_cvt_pk_bf16_f32 v24, v24, v24
v_lshlrev_b32 v24, 16, v24
v_cvt_pk_bf16_f32 v26, v26, v26
v_lshlrev_b32 v26, 16, v26
v_cvt_pk_bf16_f32 v28, v28, v28
v_lshlrev_b32 v28, 16, v28
v_cvt_pk_bf16_f32 v30, v30, v30
v_lshlrev_b32 v30, 16, v30
s_waitcnt vmcnt(3)
v_lshlrev_b32 v128, 16, v56
v_and_b32 v129, 0xffff0000, v56
v_pk_fma_f32 v[120:121], v[128:129], v[24:25], v[120:121] op_sel_hi:[1,0,1]
v_lshlrev_b32 v130, 16, v57
v_and_b32 v131, 0xffff0000, v57
v_pk_fma_f32 v[122:123], v[130:131], v[24:25], v[122:123] op_sel_hi:[1,0,1]
v_lshlrev_b32 v132, 16, v58
v_and_b32 v133, 0xffff0000, v58
v_pk_fma_f32 v[124:125], v[132:133], v[24:25], v[124:125] op_sel_hi:[1,0,1]
v_lshlrev_b32 v134, 16, v59
v_and_b32 v135, 0xffff0000, v59
v_pk_fma_f32 v[126:127], v[134:135], v[24:25], v[126:127] op_sel_hi:[1,0,1]
s_waitcnt vmcnt(2)
v_lshlrev_b32 v128, 16, v60
v_and_b32 v129, 0xffff0000, v60
v_pk_fma_f32 v[120:121], v[128:129], v[26:27], v[120:121] op_sel_hi:[1,0,1]
v_lshlrev_b32 v130, 16, v61
v_and_b32 v131, 0xffff0000, v61
v_pk_fma_f32 v[122:123], v[130:131], v[26:27], v[122:123] op_sel_hi:[1,0,1]
v_lshlrev_b32 v132, 16, v62
v_and_b32 v133, 0xffff0000, v62
v_pk_fma_f32 v[124:125], v[132:133], v[26:27], v[124:125] op_sel_hi:[1,0,1]
v_lshlrev_b32 v134, 16, v63
v_and_b32 v135, 0xffff0000, v63
v_pk_fma_f32 v[126:127], v[134:135], v[26:27], v[126:127] op_sel_hi:[1,0,1]
s_waitcnt vmcnt(1)
v_lshlrev_b32 v128, 16, v64
v_and_b32 v129, 0xffff0000, v64
v_pk_fma_f32 v[120:121], v[128:129], v[28:29], v[120:121] op_sel_hi:[1,0,1]
v_lshlrev_b32 v130, 16, v65
v_and_b32 v131, 0xffff0000, v65
v_pk_fma_f32 v[122:123], v[130:131], v[28:29], v[122:123] op_sel_hi:[1,0,1]
v_lshlrev_b32 v132, 16, v66
v_and_b32 v133, 0xffff0000, v66
v_pk_fma_f32 v[124:125], v[132:133], v[28:29], v[124:125] op_sel_hi:[1,0,1]
v_lshlrev_b32 v134, 16, v67
v_and_b32 v135, 0xffff0000, v67
v_pk_fma_f32 v[126:127], v[134:135], v[28:29], v[126:127] op_sel_hi:[1,0,1]
s_waitcnt vmcnt(0)
v_lshlrev_b32 v128, 16, v68
v_and_b32 v129, 0xffff0000, v68
v_pk_fma_f32 v[120:121], v[128:129], v[30:31], v[120:121] op_sel_hi:[1,0,1]
v_lshlrev_b32 v130, 16, v69
v_and_b32 v131, 0xffff0000, v69
v_pk_fma_f32 v[122:123], v[130:131], v[30:31], v[122:123] op_sel_hi:[1,0,1]
v_lshlrev_b32 v132, 16, v70
v_and_b32 v133, 0xffff0000, v70
v_pk_fma_f32 v[124:125], v[132:133], v[30:31], v[124:125] op_sel_hi:[1,0,1]
v_lshlrev_b32 v134, 16, v71
v_and_b32 v135, 0xffff0000, v71
v_pk_fma_f32 v[126:127], v[134:135], v[30:31], v[126:127] op_sel_hi:[1,0,1]
s_cmp_ge_u32 s2, 72
s_cbranch_scc1 K0_MNZ
s_add_u32 s16, s4, 15269888
s_addc_u32 s17, s5, 0
global_store_dword v5, v6, s[16:17]
K0_MNZ:
v_add_f32_dpp v120, v120, v120 row_ror:8 row_mask:0xf bank_mask:0xf
v_add_f32_dpp v121, v121, v121 row_ror:8 row_mask:0xf bank_mask:0xf
v_add_f32_dpp v122, v122, v122 row_ror:8 row_mask:0xf bank_mask:0xf
v_add_f32_dpp v123, v123, v123 row_ror:8 row_mask:0xf bank_mask:0xf
v_add_f32_dpp v124, v124, v124 row_ror:8 row_mask:0xf bank_mask:0xf
v_add_f32_dpp v125, v125, v125 row_ror:8 row_mask:0xf bank_mask:0xf
v_add_f32_dpp v126, v126, v126 row_ror:8 row_mask:0xf bank_mask:0xf
v_add_f32_dpp v127, v127, v127 row_ror:8 row_mask:0xf bank_mask:0xf
v_lshrrev_b32 v6, 4, v0
v_lshlrev_b32 v6, 8, v6
v_lshlrev_b32 v3, 1, v4
v_add_u32 v6, v6, v3
s_mov_b32 s16, 0x00ff00ff
s_mov_b32 s17, 0x00ff00ff
s_mov_b64 exec, s[16:17]
ds_write_b128 v6, v[120:123]
ds_write_b128 v6, v[124:127] offset:16
s_mov_b64 exec, -1
v_lshlrev_b32 v6, 2, v0
s_waitcnt lgkmcnt(0)
s_barrier
v_readfirstlane_b32 s14, v0
s_nop 3
s_cmp_ge_u32 s14, 64
s_cbranch_scc1 K0_END
ds_read_b32 v128, v6 offset:0
ds_read_b32 v129, v6 offset:256
ds_read_b32 v130, v6 offset:512
ds_read_b32 v131, v6 offset:768
ds_read_b32 v132, v6 offset:1024
ds_read_b32 v133, v6 offset:1280
ds_read_b32 v134, v6 offset:1536
ds_read_b32 v135, v6 offset:1792
ds_read_b32 v136, v6 offset:2048
ds_read_b32 v137, v6 offset:2304
ds_read_b32 v138, v6 offset:2560
ds_read_b32 v139, v6 offset:2816
ds_read_b32 v140, v6 offset:3072
ds_read_b32 v141, v6 offset:3328
ds_read_b32 v142, v6 offset:3584
ds_read_b32 v143, v6 offset:3840
s_mul_i32 s14, s12, 12288
s_lshl_b32 s15, s13, 8
s_add_u32 s14, s14, s15
s_add_u32 s14, s14, 15220736
s_add_u32 s4, s4, s14
s_addc_u32 s5, s5, 0
s_waitcnt lgkmcnt(0)
v_add_f32 v128, v128, v136
v_add_f32 v129, v129, v137
v_add_f32 v130, v130, v138
v_add_f32 v131, v131, v139
v_add_f32 v132, v132, v140
v_add_f32 v133, v133, v141
v_add_f32 v134, v134, v142
v_add_f32 v135, v135, v143
v_add_f32 v128, v128, v132
v_add_f32 v129, v129, v133
v_add_f32 v130, v130, v134
v_add_f32 v131, v131, v135
v_add_f32 v128, v128, v130
v_add_f32 v129, v129, v131
v_add_f32 v128, v128, v129
global_store_dword v6, v128, s[4:5]
s_endpgm
K0_L:
s_load_dwordx2 s[10:11], s[0:1], 0
s_sub_u32 s12, s2, 192
v_and_b32 v1, 63, v0
v_lshrrev_b32 v2, 6, v0
v_lshlrev_b32 v5, 4, v1
v_lshlrev_b32 v6, 12, v2
v_add_u32 v5, v5, v6
s_lshl_b32 s13, s12, 14
v_add_u32 v5, s13, v5
s_waitcnt lgkmcnt(0)
global_load_dwordx4 v[8:11], v5, s[10:11] offset:0
global_load_dwordx4 v[12:15], v5, s[10:11] offset:1024
global_load_dwordx4 v[16:19], v5, s[10:11] offset:2048
global_load_dwordx4 v[20:23], v5, s[10:11] offset:3072
v_and_b32 v6, 15, v1
v_lshlrev_b32 v7, 2, v2
v_add_u32 v24, 0, v7
v_xor_b32 v24, v24, v6
v_lshlrev_b32 v24, 4, v24
v_lshl_add_u32 v24, v1, 8, v24
v_add_u32 v25, 1, v7
v_xor_b32 v25, v25, v6
v_lshlrev_b32 v25, 4, v25
v_lshl_add_u32 v25, v1, 8, v25
v_add_u32 v26, 2, v7
v_xor_b32 v26, v26, v6
v_lshlrev_b32 v26, 4, v26
v_lshl_add_u32 v26, v1, 8, v26
v_add_u32 v27, 3, v7
v_xor_b32 v27, v27, v6
v_lshlrev_b32 v27, 4, v27
v_lshl_add_u32 v27, v1, 8, v27
v_lshrrev_b32 v6, 4, v0
v_and_b32 v7, 15, v0
v_xor_b32 v7, v7, v6
v_lshlrev_b32 v7, 4, v7
v_and_b32 v3, 1, v6
v_lshl_add_u32 v7, v3, 9, v7
v_lshrrev_b32 v6, 1, v6
v_lshl_add_u32 v7, v6, 10, v7
s_lshr_b32 s13, s12, 1
s_lshl_b32 s13, s13, 15
s_and_b32 s14, s12, 1
s_lshl_b32 s14, s14, 8
s_add_u32 s13, s13, s14
s_add_u32 s4, s4, s13
s_addc_u32 s5, s5, 0
v_lshlrev_b32 v6, 4, v0
s_waitcnt vmcnt(3)
v_lshlrev_b32 v32, 16, v8
v_and_b32 v33, 0xffff0000, v8
v_lshlrev_b32 v34, 16, v9
v_and_b32 v35, 0xffff0000, v9
v_lshlrev_b32 v36, 16, v10
v_and_b32 v37, 0xffff0000, v10
v_lshlrev_b32 v38, 16, v11
v_and_b32 v39, 0xffff0000, v11
s_waitcnt vmcnt(2)
v_lshlrev_b32 v40, 16, v12
v_and_b32 v41, 0xffff0000, v12
v_lshlrev_b32 v42, 16, v13
v_and_b32 v43, 0xffff0000, v13
v_lshlrev_b32 v44, 16, v14
v_and_b32 v45, 0xffff0000, v14
v_lshlrev_b32 v46, 16, v15
v_and_b32 v47, 0xffff0000, v15
s_waitcnt vmcnt(1)
v_lshlrev_b32 v48, 16, v16
v_and_b32 v49, 0xffff0000, v16
v_lshlrev_b32 v50, 16, v17
v_and_b32 v51, 0xffff0000, v17
v_lshlrev_b32 v52, 16, v18
v_and_b32 v53, 0xffff0000, v18
v_lshlrev_b32 v54, 16, v19
v_and_b32 v55, 0xffff0000, v19
s_waitcnt vmcnt(0)
v_lshlrev_b32 v56, 16, v20
v_and_b32 v57, 0xffff0000, v20
v_lshlrev_b32 v58, 16, v21
v_and_b32 v59, 0xffff0000, v21
v_lshlrev_b32 v60, 16, v22
v_and_b32 v61, 0xffff0000, v22
v_lshlrev_b32 v62, 16, v23
v_and_b32 v63, 0xffff0000, v23
v_pk_add_f32 v[64:65], v[32:33], v[34:35]
v_pk_add_f32 v[66:67], v[40:41], v[42:43]
v_pk_add_f32 v[68:69], v[48:49], v[50:51]
v_pk_add_f32 v[70:71], v[56:57], v[58:59]
v_pk_add_f32 v[64:65], v[64:65], v[36:37]
v_pk_add_f32 v[66:67], v[66:67], v[44:45]
v_pk_add_f32 v[68:69], v[68:69], v[52:53]
v_pk_add_f32 v[70:71], v[70:71], v[60:61]
v_pk_add_f32 v[64:65], v[64:65], v[38:39]
v_pk_add_f32 v[66:67], v[66:67], v[46:47]
v_pk_add_f32 v[68:69], v[68:69], v[54:55]
v_pk_add_f32 v[70:71], v[70:71], v[62:63]
v_add_f32 v64, v64, v65
v_add_f32 v66, v66, v67
v_add_f32 v68, v68, v69
v_add_f32 v70, v70, v71
v_add_f32_dpp v64, v64, v64 quad_perm:[1,0,3,2] row_mask:0xf bank_mask:0xf
v_add_f32_dpp v66, v66, v66 quad_perm:[1,0,3,2] row_mask:0xf bank_mask:0xf
v_add_f32_dpp v68, v68, v68 quad_perm:[1,0,3,2] row_mask:0xf bank_mask:0xf
v_add_f32_dpp v70, v70, v70 quad_perm:[1,0,3,2] row_mask:0xf bank_mask:0xf
v_add_f32_dpp v64, v64, v64 quad_perm:[2,3,0,1] row_mask:0xf bank_mask:0xf
v_add_f32_dpp v66, v66, v66 quad_perm:[2,3,0,1] row_mask:0xf bank_mask:0xf
v_add_f32_dpp v68, v68, v68 quad_perm:[2,3,0,1] row_mask:0xf bank_mask:0xf
v_add_f32_dpp v70, v70, v70 quad_perm:[2,3,0,1] row_mask:0xf bank_mask:0xf
v_add_f32_dpp v64, v64, v64 row_half_mirror row_mask:0xf bank_mask:0xf
v_add_f32_dpp v66, v66, v66 row_half_mirror row_mask:0xf bank_mask:0xf
v_add_f32_dpp v68, v68, v68 row_half_mirror row_mask:0xf bank_mask:0xf
v_add_f32_dpp v70, v70, v70 row_half_mirror row_mask:0xf bank_mask:0xf
v_add_f32_dpp v64, v64, v64 row_mirror row_mask:0xf bank_mask:0xf
v_add_f32_dpp v66, v66, v66 row_mirror row_mask:0xf bank_mask:0xf
v_add_f32_dpp v68, v68, v68 row_mirror row_mask:0xf bank_mask:0xf
v_add_f32_dpp v70, v70, v70 row_mirror row_mask:0xf bank_mask:0xf
v_mov_b32 v72, v64
v_mov_b32 v73, v66
v_mov_b32 v74, v68
v_mov_b32 v75, v70
v_permlane16_swap_b32 v64, v72
v_permlane16_swap_b32 v66, v73
v_permlane16_swap_b32 v68, v74
v_permlane16_swap_b32 v70, v75
v_add_f32 v64, v64, v72
v_add_f32 v66, v66, v73
v_add_f32 v68, v68, v74
v_add_f32 v70, v70, v75
v_mov_b32 v72, v64
v_mov_b32 v73, v66
v_mov_b32 v74, v68
v_mov_b32 v75, v70
v_permlane32_swap_b32 v64, v72
v_permlane32_swap_b32 v66, v73
v_permlane32_swap_b32 v68, v74
v_permlane32_swap_b32 v70, v75
v_add_f32 v64, v64, v72
v_add_f32 v66, v66, v73
v_add_f32 v68, v68, v74
v_add_f32 v70, v70, v75
v_mul_f32 v64, 0xbb000000, v64
v_mul_f32 v66, 0xbb000000, v66
v_mul_f32 v68, 0xbb000000, v68
v_mul_f32 v70, 0xbb000000, v70
v_pk_add_f32 v[32:33], v[32:33], v[64:65] op_sel_hi:[1,0]
v_pk_add_f32 v[34:35], v[34:35], v[64:65] op_sel_hi:[1,0]
v_pk_add_f32 v[36:37], v[36:37], v[64:65] op_sel_hi:[1,0]
v_pk_add_f32 v[38:39], v[38:39], v[64:65] op_sel_hi:[1,0]
v_pk_add_f32 v[40:41], v[40:41], v[66:67] op_sel_hi:[1,0]
v_pk_add_f32 v[42:43], v[42:43], v[66:67] op_sel_hi:[1,0]
v_pk_add_f32 v[44:45], v[44:45], v[66:67] op_sel_hi:[1,0]
v_pk_add_f32 v[46:47], v[46:47], v[66:67] op_sel_hi:[1,0]
v_pk_add_f32 v[48:49], v[48:49], v[68:69] op_sel_hi:[1,0]
v_pk_add_f32 v[50:51], v[50:51], v[68:69] op_sel_hi:[1,0]
v_pk_add_f32 v[52:53], v[52:53], v[68:69] op_sel_hi:[1,0]
v_pk_add_f32 v[54:55], v[54:55], v[68:69] op_sel_hi:[1,0]
v_pk_add_f32 v[56:57], v[56:57], v[70:71] op_sel_hi:[1,0]
v_pk_add_f32 v[58:59], v[58:59], v[70:71] op_sel_hi:[1,0]
v_pk_add_f32 v[60:61], v[60:61], v[70:71] op_sel_hi:[1,0]
v_pk_add_f32 v[62:63], v[62:63], v[70:71] op_sel_hi:[1,0]
v_pk_mul_f32 v[64:65], v[32:33], v[32:33]
v_pk_mul_f32 v[66:67], v[40:41], v[40:41]
v_pk_mul_f32 v[68:69], v[48:49], v[48:49]
v_pk_mul_f32 v[70:71], v[56:57], v[56:57]
v_pk_fma_f32 v[64:65], v[34:35], v[34:35], v[64:65]
v_pk_fma_f32 v[66:67], v[42:43], v[42:43], v[66:67]
v_pk_fma_f32 v[68:69], v[50:51], v[50:51], v[68:69]
v_pk_fma_f32 v[70:71], v[58:59], v[58:59], v[70:71]
v_pk_fma_f32 v[64:65], v[36:37], v[36:37], v[64:65]
v_pk_fma_f32 v[66:67], v[44:45], v[44:45], v[66:67]
v_pk_fma_f32 v[68:69], v[52:53], v[52:53], v[68:69]
v_pk_fma_f32 v[70:71], v[60:61], v[60:61], v[70:71]
v_pk_fma_f32 v[64:65], v[38:39], v[38:39], v[64:65]
v_pk_fma_f32 v[66:67], v[46:47], v[46:47], v[66:67]
v_pk_fma_f32 v[68:69], v[54:55], v[54:55], v[68:69]
v_pk_fma_f32 v[70:71], v[62:63], v[62:63], v[70:71]
v_add_f32 v64, v64, v65
v_add_f32 v66, v66, v67
v_add_f32 v68, v68, v69
v_add_f32 v70, v70, v71
v_add_f32_dpp v64, v64, v64 quad_perm:[1,0,3,2] row_mask:0xf bank_mask:0xf
v_add_f32_dpp v66, v66, v66 quad_perm:[1,0,3,2] row_mask:0xf bank_mask:0xf
v_add_f32_dpp v68, v68, v68 quad_perm:[1,0,3,2] row_mask:0xf bank_mask:0xf
v_add_f32_dpp v70, v70, v70 quad_perm:[1,0,3,2] row_mask:0xf bank_mask:0xf
v_add_f32_dpp v64, v64, v64 quad_perm:[2,3,0,1] row_mask:0xf bank_mask:0xf
v_add_f32_dpp v66, v66, v66 quad_perm:[2,3,0,1] row_mask:0xf bank_mask:0xf
v_add_f32_dpp v68, v68, v68 quad_perm:[2,3,0,1] row_mask:0xf bank_mask:0xf
v_add_f32_dpp v70, v70, v70 quad_perm:[2,3,0,1] row_mask:0xf bank_mask:0xf
v_add_f32_dpp v64, v64, v64 row_half_mirror row_mask:0xf bank_mask:0xf
v_add_f32_dpp v66, v66, v66 row_half_mirror row_mask:0xf bank_mask:0xf
v_add_f32_dpp v68, v68, v68 row_half_mirror row_mask:0xf bank_mask:0xf
v_add_f32_dpp v70, v70, v70 row_half_mirror row_mask:0xf bank_mask:0xf
v_add_f32_dpp v64, v64, v64 row_mirror row_mask:0xf bank_mask:0xf
v_add_f32_dpp v66, v66, v66 row_mirror row_mask:0xf bank_mask:0xf
v_add_f32_dpp v68, v68, v68 row_mirror row_mask:0xf bank_mask:0xf
v_add_f32_dpp v70, v70, v70 row_mirror row_mask:0xf bank_mask:0xf
v_mov_b32 v72, v64
v_mov_b32 v73, v66
v_mov_b32 v74, v68
v_mov_b32 v75, v70
v_permlane16_swap_b32 v64, v72
v_permlane16_swap_b32 v66, v73
v_permlane16_swap_b32 v68, v74
v_permlane16_swap_b32 v70, v75
v_add_f32 v64, v64, v72
v_add_f32 v66, v66, v73
v_add_f32 v68, v68, v74
v_add_f32 v70, v70, v75
v_mov_b32 v72, v64
v_mov_b32 v73, v66
v_mov_b32 v74, v68
v_mov_b32 v75, v70
v_permlane32_swap_b32 v64, v72
v_permlane32_swap_b32 v66, v73
v_permlane32_swap_b32 v68, v74
v_permlane32_swap_b32 v70, v75
v_add_f32 v64, v64, v72
v_add_f32 v66, v66, v73
v_add_f32 v68, v68, v74
v_add_f32 v70, v70, v75
v_mov_b32 v72, 0x3727c5ac
v_mov_b32 v73, 0x3727c5ac
v_mov_b32 v74, 0x3727c5ac
v_mov_b32 v75, 0x3727c5ac
v_fmac_f32 v72, 0x3b000000, v64
v_fmac_f32 v73, 0x3b000000, v66
v_fmac_f32 v74, 0x3b000000, v68
v_fmac_f32 v75, 0x3b000000, v70
v_rsq_f32 v64, v72
v_rsq_f32 v66, v73
v_rsq_f32 v68, v74
v_rsq_f32 v70, v75
v_pk_mul_f32 v[32:33], v[32:33], v[64:65] op_sel_hi:[1,0]
v_pk_mul_f32 v[34:35], v[34:35], v[64:65] op_sel_hi:[1,0]
v_pk_mul_f32 v[36:37], v[36:37], v[64:65] op_sel_hi:[1,0]
v_pk_mul_f32 v[38:39], v[38:39], v[64:65] op_sel_hi:[1,0]
v_cvt_pk_bf16_f32 v8, v32, v33
v_cvt_pk_bf16_f32 v9, v34, v35
v_cvt_pk_bf16_f32 v10, v36, v37
v_cvt_pk_bf16_f32 v11, v38, v39
ds_write_b128 v24, v[8:11]
v_pk_mul_f32 v[40:41], v[40:41], v[66:67] op_sel_hi:[1,0]
v_pk_mul_f32 v[42:43], v[42:43], v[66:67] op_sel_hi:[1,0]
v_pk_mul_f32 v[44:45], v[44:45], v[66:67] op_sel_hi:[1,0]
v_pk_mul_f32 v[46:47], v[46:47], v[66:67] op_sel_hi:[1,0]
v_cvt_pk_bf16_f32 v12, v40, v41
v_cvt_pk_bf16_f32 v13, v42, v43
v_cvt_pk_bf16_f32 v14, v44, v45
v_cvt_pk_bf16_f32 v15, v46, v47
ds_write_b128 v25, v[12:15]
v_pk_mul_f32 v[48:49], v[48:49], v[68:69] op_sel_hi:[1,0]
v_pk_mul_f32 v[50:51], v[50:51], v[68:69] op_sel_hi:[1,0]
v_pk_mul_f32 v[52:53], v[52:53], v[68:69] op_sel_hi:[1,0]
v_pk_mul_f32 v[54:55], v[54:55], v[68:69] op_sel_hi:[1,0]
v_cvt_pk_bf16_f32 v16, v48, v49
v_cvt_pk_bf16_f32 v17, v50, v51
v_cvt_pk_bf16_f32 v18, v52, v53
v_cvt_pk_bf16_f32 v19, v54, v55
ds_write_b128 v26, v[16:19]
v_pk_mul_f32 v[56:57], v[56:57], v[70:71] op_sel_hi:[1,0]
v_pk_mul_f32 v[58:59], v[58:59], v[70:71] op_sel_hi:[1,0]
v_pk_mul_f32 v[60:61], v[60:61], v[70:71] op_sel_hi:[1,0]
v_pk_mul_f32 v[62:63], v[62:63], v[70:71] op_sel_hi:[1,0]
v_cvt_pk_bf16_f32 v20, v56, v57
v_cvt_pk_bf16_f32 v21, v58, v59
v_cvt_pk_bf16_f32 v22, v60, v61
v_cvt_pk_bf16_f32 v23, v62, v63
ds_write_b128 v27, v[20:23]
s_waitcnt lgkmcnt(0)
s_barrier
ds_read_b128 v[8:11], v6 offset:0
ds_read_b128 v[12:15], v6 offset:4096
ds_read_b128 v[16:19], v6 offset:8192
ds_read_b128 v[20:23], v6 offset:12288
s_waitcnt lgkmcnt(3)
global_store_dwordx4 v7, v[8:11], s[4:5]
v_add_u32 v7, 8192, v7
s_waitcnt lgkmcnt(2)
global_store_dwordx4 v7, v[12:15], s[4:5]
v_add_u32 v7, 8192, v7
s_waitcnt lgkmcnt(1)
global_store_dwordx4 v7, v[16:19], s[4:5]
v_add_u32 v7, 8192, v7
s_waitcnt lgkmcnt(0)
global_store_dwordx4 v7, v[20:23], s[4:5]
s_endpgm
K0_F:
s_load_dwordx2 s[10:11], s[0:1], 8
s_sub_u32 s12, s2, 320
s_and_b32 s13, s12, 31
s_lshr_b32 s12, s12, 5
v_and_b32 v1, 127, v0
v_lshrrev_b32 v2, 7, v0
v_mul_u32_u24 v3, 24576, v2
v_lshl_add_u32 v3, v1, 3, v3
s_mul_i32 s14, s13, 49152
s_lshl_b32 s15, s12, 10
s_add_u32 s14, s14, s15
v_add_u32 v3, s14, v3
v_add_u32 v4, 6144, v3
v_add_u32 v5, 12288, v3
v_add_u32 v6, 18432, v3
s_waitcnt lgkmcnt(0)
global_load_dwordx2 v[8:9], v3, s[10:11] offset:0
global_load_dwordx2 v[10:11], v3, s[10:11] offset:3072
global_load_dwordx2 v[12:13], v4, s[10:11] offset:0
global_load_dwordx2 v[14:15], v4, s[10:11] offset:3072
global_load_dwordx2 v[16:17], v5, s[10:11] offset:0
global_load_dwordx2 v[18:19], v5, s[10:11] offset:3072
global_load_dwordx2 v[20:21], v6, s[10:11] offset:0
global_load_dwordx2 v[22:23], v6, s[10:11] offset:3072
v_lshrrev_b32 v7, 3, v1
v_lshlrev_b32 v7, 15, v7
v_and_b32 v1, 7, v1
v_lshl_add_u32 v7, v1, 6, v7
v_lshl_add_u32 v7, v2, 9, v7
s_lshl_b32 s14, s12, 19
s_lshl_b32 s15, s13, 10
s_add_u32 s14, s14, s15
s_add_u32 s14, s14, 2097152
s_add_u32 s4, s4, s14
s_addc_u32 s5, s5, 0
s_mov_b32 s14, 0x05040100
s_mov_b32 s15, 0x07060302
s_waitcnt vmcnt(0)
v_perm_b32 v32, v10, v8, s14
v_perm_b32 v33, v14, v12, s14
v_perm_b32 v34, v18, v16, s14
v_perm_b32 v35, v22, v20, s14
global_store_dwordx4 v7, v[32:35], s[4:5] offset:0
v_perm_b32 v36, v10, v8, s15
v_perm_b32 v37, v14, v12, s15
v_perm_b32 v38, v18, v16, s15
v_perm_b32 v39, v22, v20, s15
global_store_dwordx4 v7, v[36:39], s[4:5] offset:16
v_perm_b32 v40, v11, v9, s14
v_perm_b32 v41, v15, v13, s14
v_perm_b32 v42, v19, v17, s14
v_perm_b32 v43, v23, v21, s14
global_store_dwordx4 v7, v[40:43], s[4:5] offset:32
v_perm_b32 v44, v11, v9, s15
v_perm_b32 v45, v15, v13, s15
v_perm_b32 v46, v19, v17, s15
v_perm_b32 v47, v23, v21, s15
global_store_dwordx4 v7, v[44:47], s[4:5] offset:48
s_endpgm
K0_D:
s_load_dwordx2 s[10:11], s[0:1], 56
s_sub_u32 s12, s2, 448
v_lshrrev_b32 v1, 5, v0
v_and_b32 v2, 31, v0
v_lshlrev_b32 v3, 11, v1
v_lshl_add_u32 v3, v2, 4, v3
s_lshl_b32 s13, s12, 14
v_add_u32 v3, s13, v3
s_waitcnt lgkmcnt(0)
global_load_dwordx4 v[8:11], v3, s[10:11] offset:0
global_load_dwordx4 v[12:15], v3, s[10:11] offset:1024
global_load_dwordx4 v[16:19], v3, s[10:11] offset:512
global_load_dwordx4 v[20:23], v3, s[10:11] offset:1536
v_and_b32 v4, 7, v2
v_xor_b32 v4, v4, v1
v_lshlrev_b32 v4, 4, v4
v_lshl_add_u32 v4, v2, 8, v4
v_lshlrev_b32 v5, 4, v0
v_bfe_u32 v6, v0, 4, 3
v_and_b32 v7, 7, v0
v_xor_b32 v6, v6, v7
v_lshlrev_b32 v6, 4, v6
v_lshrrev_b32 v7, 3, v0
v_mul_u32_u24 v7, 11008, v7
v_add_u32 v6, v6, v7
s_lshl_b32 s13, s12, 7
s_add_u32 s13, s13, 20971520
s_add_u32 s4, s4, s13
s_addc_u32 s5, s5, 0
v_add_u32 v24, 8192, v4
s_waitcnt vmcnt(2)
ds_write2_b64 v4, v[8:9], v[12:13] offset0:0 offset1:1
ds_write2_b64 v4, v[10:11], v[14:15] offset0:16 offset1:17
s_waitcnt vmcnt(0)
ds_write2_b64 v24, v[16:17], v[20:21] offset0:0 offset1:1
ds_write2_b64 v24, v[18:19], v[22:23] offset0:16 offset1:17
s_waitcnt lgkmcnt(0)
s_barrier
ds_read_b128 v[8:11], v5 offset:0
ds_read_b128 v[12:15], v5 offset:4096
ds_read_b128 v[16:19], v5 offset:8192
ds_read_b128 v[20:23], v5 offset:12288
s_waitcnt lgkmcnt(3)
global_store_dwordx4 v6, v[8:11], s[4:5]
v_add_u32 v6, 352256, v6
s_waitcnt lgkmcnt(2)
global_store_dwordx4 v6, v[12:15], s[4:5]
v_add_u32 v6, 352256, v6
s_waitcnt lgkmcnt(1)
global_store_dwordx4 v6, v[16:19], s[4:5]
v_add_u32 v6, 352256, v6
s_waitcnt lgkmcnt(0)
global_store_dwordx4 v6, v[20:23], s[4:5]
s_endpgm
K0_R4:
s_load_dwordx2 s[10:11], s[0:1], 16
s_sub_u32 s12, s2, 416
v_lshlrev_b32 v1, 2, v0
s_lshl_b32 s13, s12, 14
v_add_u32 v1, s13, v1
s_waitcnt lgkmcnt(0)
global_load_dword v8, v1, s[10:11] offset:0
global_load_dword v9, v1, s[10:11] offset:1024
global_load_dword v10, v1, s[10:11] offset:2048
global_load_dword v11, v1, s[10:11] offset:3072
v_add_u32 v1, 4096, v1
global_load_dword v12, v1, s[10:11] offset:0
global_load_dword v13, v1, s[10:11] offset:1024
global_load_dword v14, v1, s[10:11] offset:2048
global_load_dword v15, v1, s[10:11] offset:3072
v_add_u32 v1, 4096, v1
global_load_dword v16, v1, s[10:11] offset:0
global_load_dword v17, v1, s[10:11] offset:1024
global_load_dword v18, v1, s[10:11] offset:2048
global_load_dword v19, v1, s[10:11] offset:3072
v_add_u32 v1, 4096, v1
global_load_dword v20, v1, s[10:11] offset:0
global_load_dword v21, v1, s[10:11] offset:1024
global_load_dword v22, v1, s[10:11] offset:2048
global_load_dword v23, v1, s[10:11] offset:3072
v_and_b32 v2, 15, v0
v_lshlrev_b32 v2, 1, v2
v_and_b32 v3, 3, v2
v_bfe_u32 v4, v2, 2, 2
v_lshlrev_b32 v4, 3, v4
v_add_u32 v3, v3, v4
v_lshrrev_b32 v4, 4, v2
v_lshlrev_b32 v4, 2, v4
v_add_u32 v3, v3, v4
v_lshlrev_b32 v3, 4, v3
v_lshrrev_b32 v4, 4, v0
v_lshlrev_b32 v4, 15, v4
v_add_u32 v3, v3, v4
s_lshl_b32 s13, s12, 10
s_add_u32 s13, s13, 14680064
s_add_u32 s4, s4, s13
s_addc_u32 s5, s5, 0
s_mov_b32 s14, 0x05040100
s_mov_b32 s15, 0x07060302
s_waitcnt vmcnt(0)
v_perm_b32 v32, v9, v8, s14
v_perm_b32 v36, v9, v8, s15
v_perm_b32 v33, v11, v10, s14
v_perm_b32 v37, v11, v10, s15
v_perm_b32 v34, v17, v16, s14
v_perm_b32 v38, v17, v16, s15
v_perm_b32 v35, v19, v18, s14
v_perm_b32 v39, v19, v18, s15
global_store_dwordx4 v3, v[32:35], s[4:5] offset:0
global_store_dwordx4 v3, v[36:39], s[4:5] offset:16
v_perm_b32 v40, v13, v12, s14
v_perm_b32 v44, v13, v12, s15
v_perm_b32 v41, v15, v14, s14
v_perm_b32 v45, v15, v14, s15
v_perm_b32 v42, v21, v20, s14
v_perm_b32 v46, v21, v20, s15
v_perm_b32 v43, v23, v22, s14
v_perm_b32 v47, v23, v22, s15
global_store_dwordx4 v3, v[40:43], s[4:5] offset:512
global_store_dwordx4 v3, v[44:47], s[4:5] offset:528
s_endpgm
K0_P:
s_getpc_b64 s[60:61]
K0_PC:
s_add_u32 s60, s60, k1_kernel-K0_PC
s_addc_u32 s61, s61, 0
v_lshlrev_b32 v8, 4, v0
v_mov_b32 v9, s61
v_add_co_u32 v8, vcc, s60, v8
s_nop 1
v_addc_co_u32 v9, vcc, 0, v9, vcc
global_load_dwordx4 v[10:13], v[8:9], off
v_add_co_u32 v8, vcc, 4096, v8
s_nop 1
v_addc_co_u32 v9, vcc, 0, v9, vcc
global_load_dwordx4 v[10:13], v[8:9], off
v_add_co_u32 v8, vcc, 4096, v8
s_nop 1
v_addc_co_u32 v9, vcc, 0, v9, vcc
global_load_dwordx4 v[10:13], v[8:9], off
v_add_co_u32 v8, vcc, 4096, v8
s_nop 1
v_addc_co_u32 v9, vcc, 0, v9, vcc
global_load_dwordx4 v[10:13], v[8:9], off
v_add_co_u32 v8, vcc, 4096, v8
s_nop 1
v_addc_co_u32 v9, vcc, 0, v9, vcc
global_load_dwordx4 v[10:13], v[8:9], off
v_add_co_u32 v8, vcc, 4096, v8
s_nop 1
v_addc_co_u32 v9, vcc, 0, v9, vcc
global_load_dwordx4 v[10:13], v[8:9], off
s_getpc_b64 s[60:61]
K0_PC2:
s_add_u32 s60, s60, K4_END-4096-K0_PC2
s_addc_u32 s61, s61, 0
v_lshlrev_b32 v8, 4, v0
v_mov_b32 v9, s61
v_add_co_u32 v8, vcc, s60, v8
s_nop 1
v_addc_co_u32 v9, vcc, 0, v9, vcc
global_load_dwordx4 v[10:13], v[8:9], off
s_waitcnt vmcnt(0)
K0_END:
s_endpgm
.globl k1_kernel
.p2align 8
.type k1_kernel,@function
k1_kernel:
s_cmp_ge_u32 s2, 256
s_cbranch_scc1 K1_END
s_load_dwordx2 s[4:5], s[0:1], 96
s_load_dwordx2 s[26:27], s[0:1], 32
s_and_b32 s6, s2, 7
s_lshr_b32 s7, s2, 3
s_lshr_b32 s8, s6, 1
s_lshl_b32 s8, s8, 2
s_and_b32 s9, s7, 3
s_add_u32 s8, s8, s9
s_and_b32 s9, s6, 1
s_lshl_b32 s9, s9, 3
s_lshr_b32 s10, s7, 2
s_add_u32 s9, s9, s10
v_readfirstlane_b32 s10, v0
s_nop 3
s_lshr_b32 s10, s10, 6
v_and_b32 v1, 63, v0
v_lshlrev_b32 v2, 4, v1
s_lshl_b32 s11, s8, 2
s_add_u32 s11, s11, s10
s_lshl_b32 s12, s9, 15
s_lshl_b32 s13, s10, 11
v_lshlrev_b32 v6, 4, v0
s_waitcnt lgkmcnt(0)
s_add_u32 s20, s4, 15220736
s_addc_u32 s21, s5, 0
global_load_dwordx4 v[196:199], v6, s[20:21]
s_add_u32 s20, s20, 12288
s_addc_u32 s21, s21, 0
global_load_dwordx4 v[200:203], v6, s[20:21]
s_add_u32 s20, s20, 12288
s_addc_u32 s21, s21, 0
global_load_dwordx4 v[204:207], v6, s[20:21]
s_add_u32 s20, s20, 12288
s_addc_u32 s21, s21, 0
global_load_dwordx4 v[208:211], v6, s[20:21]
s_add_u32 s18, s12, s13
s_add_u32 s18, s18, 2097152
s_add_u32 s14, s4, s18
s_addc_u32 s15, s5, 0
s_lshl_b32 s18, s11, 15
s_add_u32 s18, s18, 4096
s_add_u32 s16, s4, s18
s_addc_u32 s17, s5, 0
v_add_u32 v3, 0, v2
v_add_u32 v4, 524288, v2
v_add_u32 v5, 1048576, v2
s_mov_b64 s[28:29], s[14:15]
s_mov_b64 s[36:37], s[16:17]
s_add_u32 s30, s14, 8192
s_addc_u32 s31, s15, 0
s_add_u32 s38, s16, 8192
s_addc_u32 s39, s17, 0
s_add_u32 s32, s14, 16384
s_addc_u32 s33, s15, 0
s_add_u32 s40, s16, 16384
s_addc_u32 s41, s17, 0
s_add_u32 s34, s14, 24576
s_addc_u32 s35, s15, 0
s_add_u32 s42, s16, 24576
s_addc_u32 s43, s17, 0
global_load_dwordx4 v[16:19], v3, s[28:29] offset:0
global_load_dwordx4 v[24:27], v4, s[28:29] offset:0
global_load_dwordx4 v[32:35], v5, s[28:29] offset:0
global_load_dwordx4 v[20:23], v3, s[28:29] offset:1024
global_load_dwordx4 v[28:31], v4, s[28:29] offset:1024
global_load_dwordx4 v[36:39], v5, s[28:29] offset:1024
global_load_dwordx4 v[40:43], v3, s[30:31] offset:0
global_load_dwordx4 v[48:51], v4, s[30:31] offset:0
global_load_dwordx4 v[56:59], v5, s[30:31] offset:0
global_load_dwordx4 v[44:47], v3, s[30:31] offset:1024
global_load_dwordx4 v[52:55], v4, s[30:31] offset:1024
global_load_dwordx4 v[60:63], v5, s[30:31] offset:1024
global_load_dwordx4 a[0:3], v2, s[36:37] offset:-4096
global_load_dwordx4 a[4:7], v2, s[36:37] offset:-3072
global_load_dwordx4 a[8:11], v2, s[36:37] offset:-2048
global_load_dwordx4 a[12:15], v2, s[36:37] offset:-1024
global_load_dwordx4 a[16:19], v2, s[36:37] offset:0
global_load_dwordx4 a[20:23], v2, s[36:37] offset:1024
global_load_dwordx4 a[24:27], v2, s[36:37] offset:2048
global_load_dwordx4 a[28:31], v2, s[36:37] offset:3072
v_add_u32 v7, 0, v2
v_add_u32 v8, 32768, v2
v_add_u32 v9, 65536, v2
v_add_u32 v10, s13, v7
v_add_u32 v11, s13, v8
v_add_u32 v12, s13, v9
v_lshrrev_b32 v13, 5, v1
v_lshlrev_b32 v13, 5, v13
s_lshl_b32 s18, s10, 7
s_add_u32 s18, s18, 98304
v_add_u32 v13, s18, v13
v_and_b32 v14, 7, v1
v_lshlrev_b32 v14, 2, v14
v_add_u32 v13, v13, v14
v_and_b32 v14, 8, v1
v_xor_b32 v14, 8, v14
v_lshlrev_b32 v14, 8, v14
v_add_u32 v13, v13, v14
s_mov_b32 s52, 0xffff0000
s_mul_i32 s53, s10, 384
v_and_b32 v14, 31, v1
v_lshlrev_b32 v14, 2, v14
v_add_u32 v14, 102400, v14
v_lshlrev_b32 v15, 2, v1
v_add_u32 v15, 102400, v15
v_mov_b32 v236, 0
v_mov_b32 v237, 0
v_mov_b32 v238, 0
v_mov_b32 v239, 0
v_mov_b32 v240, 0
v_mov_b32 v241, 0
s_lshl_b32 s18, s6, 10
v_lshlrev_b32 v247, 2, v0
v_add_u32 v247, s18, v247
s_waitcnt vmcnt(20)
v_pk_add_f32 v[196:197], v[196:197], v[200:201]
v_pk_add_f32 v[204:205], v[204:205], v[208:209]
v_pk_add_f32 v[196:197], v[196:197], v[204:205]
v_pk_add_f32 v[198:199], v[198:199], v[202:203]
v_pk_add_f32 v[206:207], v[206:207], v[210:211]
v_pk_add_f32 v[198:199], v[198:199], v[206:207]
v_cvt_pk_bf16_f32 v196, v196, v196
v_lshlrev_b32 v196, 16, v196
v_cvt_pk_bf16_f32 v197, v197, v197
v_lshlrev_b32 v197, 16, v197
v_cvt_pk_bf16_f32 v198, v198, v198
v_lshlrev_b32 v198, 16, v198
v_cvt_pk_bf16_f32 v199, v199, v199
v_lshlrev_b32 v199, 16, v199
s_cmp_lt_u32 s10, 2
s_cbranch_scc1 K1_NS
v_add_f32 v196, 1.0, v196
v_add_f32 v197, 1.0, v197
v_add_f32 v198, 1.0, v198
v_add_f32 v199, 1.0, v199
v_cvt_pk_bf16_f32 v196, v196, v196
v_lshlrev_b32 v196, 16, v196
v_cvt_pk_bf16_f32 v197, v197, v197
v_lshlrev_b32 v197, 16, v197
v_cvt_pk_bf16_f32 v198, v198, v198
v_lshlrev_b32 v198, 16, v198
v_cvt_pk_bf16_f32 v199, v199, v199
v_lshlrev_b32 v199, 16, v199
K1_NS:
v_add_u32 v6, 98304, v6
ds_write_b128 v6, v[196:199]
s_add_u32 s44, s4, 15224832
s_addc_u32 s45, s5, 0
s_add_u32 s46, s4, 15237120
s_addc_u32 s47, s5, 0
s_add_u32 s48, s4, 15249408
s_addc_u32 s49, s5, 0
s_add_u32 s50, s4, 15261696
s_addc_u32 s51, s5, 0
s_waitcnt lgkmcnt(0)
s_barrier
ds_read_b32 v248, v13 offset:0
ds_read_b32 v249, v13 offset:64
ds_read_b32 v250, v13 offset:512
ds_read_b32 v251, v13 offset:576
ds_read_b32 v252, v13 offset:1024
ds_read_b32 v253, v13 offset:1088
ds_read_b32 v254, v13 offset:1536
ds_read_b32 v255, v13 offset:1600
v_lshrrev_b32 v6, 1, v247
v_and_b32 v6, 1023, v6
s_waitcnt lgkmcnt(0)
s_waitcnt vmcnt(14)
v_lshlrev_b32 v228, 16, v16
v_and_b32 v229, s52, v16
v_lshlrev_b32 v230, 16, v17
v_and_b32 v231, s52, v17
v_fmac_f32_dpp v236, v248, v228 row_newbcast:8 row_mask:0xf bank_mask:0xf
v_fmac_f32_dpp v237, v248, v229 row_newbcast:9 row_mask:0xf bank_mask:0xf
v_mul_f32_dpp v228, v248, v228 row_newbcast:0 row_mask:0xf bank_mask:0xf
v_mul_f32_dpp v229, v248, v229 row_newbcast:1 row_mask:0xf bank_mask:0xf
v_fmac_f32_dpp v236, v248, v230 row_newbcast:10 row_mask:0xf bank_mask:0xf
v_fmac_f32_dpp v237, v248, v231 row_newbcast:11 row_mask:0xf bank_mask:0xf
v_mul_f32_dpp v230, v248, v230 row_newbcast:2 row_mask:0xf bank_mask:0xf
v_mul_f32_dpp v231, v248, v231 row_newbcast:3 row_mask:0xf bank_mask:0xf
v_cvt_pk_bf16_f32 v16, v228, v229
v_cvt_pk_bf16_f32 v17, v230, v231
global_load_dwordx4 v[64:67], v3, s[32:33] offset:0
v_lshlrev_b32 v228, 16, v18
v_and_b32 v229, s52, v18
v_lshlrev_b32 v230, 16, v19
v_and_b32 v231, s52, v19
v_fmac_f32_dpp v236, v248, v228 row_newbcast:12 row_mask:0xf bank_mask:0xf
v_fmac_f32_dpp v237, v248, v229 row_newbcast:13 row_mask:0xf bank_mask:0xf
v_mul_f32_dpp v228, v248, v228 row_newbcast:4 row_mask:0xf bank_mask:0xf
v_mul_f32_dpp v229, v248, v229 row_newbcast:5 row_mask:0xf bank_mask:0xf
v_fmac_f32_dpp v236, v248, v230 row_newbcast:14 row_mask:0xf bank_mask:0xf
v_fmac_f32_dpp v237, v248, v231 row_newbcast:15 row_mask:0xf bank_mask:0xf
v_mul_f32_dpp v230, v248, v230 row_newbcast:6 row_mask:0xf bank_mask:0xf
v_mul_f32_dpp v231, v248, v231 row_newbcast:7 row_mask:0xf bank_mask:0xf
v_cvt_pk_bf16_f32 v18, v228, v229
v_cvt_pk_bf16_f32 v19, v230, v231
ds_write_b128 v10, v[16:19] offset:0
global_load_dwordx4 v[72:75], v4, s[32:33] offset:0
global_load_dwordx4 v[80:83], v5, s[32:33] offset:0
v_lshlrev_b32 v228, 16, v24
v_and_b32 v229, s52, v24
v_lshlrev_b32 v230, 16, v25
v_and_b32 v231, s52, v25
v_fmac_f32_dpp v238, v248, v228 row_newbcast:8 row_mask:0xf bank_mask:0xf
v_fmac_f32_dpp v239, v248, v229 row_newbcast:9 row_mask:0xf bank_mask:0xf
v_mul_f32_dpp v228, v248, v228 row_newbcast:0 row_mask:0xf bank_mask:0xf
v_mul_f32_dpp v229, v248, v229 row_newbcast:1 row_mask:0xf bank_mask:0xf
v_fmac_f32_dpp v238, v248, v230 row_newbcast:10 row_mask:0xf bank_mask:0xf
v_fmac_f32_dpp v239, v248, v231 row_newbcast:11 row_mask:0xf bank_mask:0xf
v_mul_f32_dpp v230, v248, v230 row_newbcast:2 row_mask:0xf bank_mask:0xf
v_mul_f32_dpp v231, v248, v231 row_newbcast:3 row_mask:0xf bank_mask:0xf
v_cvt_pk_bf16_f32 v24, v228, v229
v_cvt_pk_bf16_f32 v25, v230, v231
global_load_dwordx4 v[68:71], v3, s[32:33] offset:1024
v_lshlrev_b32 v228, 16, v26
v_and_b32 v229, s52, v26
v_lshlrev_b32 v230, 16, v27
v_and_b32 v231, s52, v27
v_fmac_f32_dpp v238, v248, v228 row_newbcast:12 row_mask:0xf bank_mask:0xf
v_fmac_f32_dpp v239, v248, v229 row_newbcast:13 row_mask:0xf bank_mask:0xf
v_mul_f32_dpp v228, v248, v228 row_newbcast:4 row_mask:0xf bank_mask:0xf
v_mul_f32_dpp v229, v248, v229 row_newbcast:5 row_mask:0xf bank_mask:0xf
v_fmac_f32_dpp v238, v248, v230 row_newbcast:14 row_mask:0xf bank_mask:0xf
v_fmac_f32_dpp v239, v248, v231 row_newbcast:15 row_mask:0xf bank_mask:0xf
v_mul_f32_dpp v230, v248, v230 row_newbcast:6 row_mask:0xf bank_mask:0xf
v_mul_f32_dpp v231, v248, v231 row_newbcast:7 row_mask:0xf bank_mask:0xf
v_cvt_pk_bf16_f32 v26, v228, v229
v_cvt_pk_bf16_f32 v27, v230, v231
ds_write_b128 v11, v[24:27] offset:0
global_load_dwordx4 v[76:79], v4, s[32:33] offset:1024
global_load_dwordx4 v[84:87], v5, s[32:33] offset:1024
v_lshlrev_b32 v228, 16, v32
v_and_b32 v229, s52, v32
v_lshlrev_b32 v230, 16, v33
v_and_b32 v231, s52, v33
v_fmac_f32_dpp v240, v248, v228 row_newbcast:8 row_mask:0xf bank_mask:0xf
v_fmac_f32_dpp v241, v248, v229 row_newbcast:9 row_mask:0xf bank_mask:0xf
v_mul_f32_dpp v228, v248, v228 row_newbcast:0 row_mask:0xf bank_mask:0xf
v_mul_f32_dpp v229, v248, v229 row_newbcast:1 row_mask:0xf bank_mask:0xf
v_fmac_f32_dpp v240, v248, v230 row_newbcast:10 row_mask:0xf bank_mask:0xf
v_fmac_f32_dpp v241, v248, v231 row_newbcast:11 row_mask:0xf bank_mask:0xf
v_mul_f32_dpp v230, v248, v230 row_newbcast:2 row_mask:0xf bank_mask:0xf
v_mul_f32_dpp v231, v248, v231 row_newbcast:3 row_mask:0xf bank_mask:0xf
v_cvt_pk_bf16_f32 v32, v228, v229
v_cvt_pk_bf16_f32 v33, v230, v231
global_load_dwordx4 a[32:35], v2, s[38:39] offset:-4096
v_lshlrev_b32 v228, 16, v34
v_and_b32 v229, s52, v34
v_lshlrev_b32 v230, 16, v35
v_and_b32 v231, s52, v35
v_fmac_f32_dpp v240, v248, v228 row_newbcast:12 row_mask:0xf bank_mask:0xf
v_fmac_f32_dpp v241, v248, v229 row_newbcast:13 row_mask:0xf bank_mask:0xf
v_mul_f32_dpp v228, v248, v228 row_newbcast:4 row_mask:0xf bank_mask:0xf
v_mul_f32_dpp v229, v248, v229 row_newbcast:5 row_mask:0xf bank_mask:0xf
v_fmac_f32_dpp v240, v248, v230 row_newbcast:14 row_mask:0xf bank_mask:0xf
v_fmac_f32_dpp v241, v248, v231 row_newbcast:15 row_mask:0xf bank_mask:0xf
v_mul_f32_dpp v230, v248, v230 row_newbcast:6 row_mask:0xf bank_mask:0xf
v_mul_f32_dpp v231, v248, v231 row_newbcast:7 row_mask:0xf bank_mask:0xf
v_cvt_pk_bf16_f32 v34, v228, v229
v_cvt_pk_bf16_f32 v35, v230, v231
ds_write_b128 v12, v[32:35] offset:0
global_load_dwordx4 a[36:39], v2, s[38:39] offset:-3072
global_load_dwordx4 a[40:43], v2, s[38:39] offset:-2048
v_lshlrev_b32 v228, 16, v20
v_and_b32 v229, s52, v20
v_lshlrev_b32 v230, 16, v21
v_and_b32 v231, s52, v21
v_fmac_f32_dpp v236, v249, v228 row_newbcast:8 row_mask:0xf bank_mask:0xf
v_fmac_f32_dpp v237, v249, v229 row_newbcast:9 row_mask:0xf bank_mask:0xf
v_mul_f32_dpp v228, v249, v228 row_newbcast:0 row_mask:0xf bank_mask:0xf
v_mul_f32_dpp v229, v249, v229 row_newbcast:1 row_mask:0xf bank_mask:0xf
v_fmac_f32_dpp v236, v249, v230 row_newbcast:10 row_mask:0xf bank_mask:0xf
v_fmac_f32_dpp v237, v249, v231 row_newbcast:11 row_mask:0xf bank_mask:0xf
v_mul_f32_dpp v230, v249, v230 row_newbcast:2 row_mask:0xf bank_mask:0xf
v_mul_f32_dpp v231, v249, v231 row_newbcast:3 row_mask:0xf bank_mask:0xf
v_cvt_pk_bf16_f32 v20, v228, v229
v_cvt_pk_bf16_f32 v21, v230, v231
global_load_dwordx4 a[44:47], v2, s[38:39] offset:-1024
v_lshlrev_b32 v228, 16, v22
v_and_b32 v229, s52, v22
v_lshlrev_b32 v230, 16, v23
v_and_b32 v231, s52, v23
v_fmac_f32_dpp v236, v249, v228 row_newbcast:12 row_mask:0xf bank_mask:0xf
v_fmac_f32_dpp v237, v249, v229 row_newbcast:13 row_mask:0xf bank_mask:0xf
v_mul_f32_dpp v228, v249, v228 row_newbcast:4 row_mask:0xf bank_mask:0xf
v_mul_f32_dpp v229, v249, v229 row_newbcast:5 row_mask:0xf bank_mask:0xf
v_fmac_f32_dpp v236, v249, v230 row_newbcast:14 row_mask:0xf bank_mask:0xf
v_fmac_f32_dpp v237, v249, v231 row_newbcast:15 row_mask:0xf bank_mask:0xf
v_mul_f32_dpp v230, v249, v230 row_newbcast:6 row_mask:0xf bank_mask:0xf
v_mul_f32_dpp v231, v249, v231 row_newbcast:7 row_mask:0xf bank_mask:0xf
v_cvt_pk_bf16_f32 v22, v228, v229
v_cvt_pk_bf16_f32 v23, v230, v231
ds_write_b128 v10, v[20:23] offset:1024
global_load_dwordx4 a[48:51], v2, s[38:39] offset:0
global_load_dwordx4 a[52:55], v2, s[38:39] offset:1024
v_lshlrev_b32 v228, 16, v28
v_and_b32 v229, s52, v28
v_lshlrev_b32 v230, 16, v29
v_and_b32 v231, s52, v29
v_fmac_f32_dpp v238, v249, v228 row_newbcast:8 row_mask:0xf bank_mask:0xf
v_fmac_f32_dpp v239, v249, v229 row_newbcast:9 row_mask:0xf bank_mask:0xf
v_mul_f32_dpp v228, v249, v228 row_newbcast:0 row_mask:0xf bank_mask:0xf
v_mul_f32_dpp v229, v249, v229 row_newbcast:1 row_mask:0xf bank_mask:0xf
v_fmac_f32_dpp v238, v249, v230 row_newbcast:10 row_mask:0xf bank_mask:0xf
v_fmac_f32_dpp v239, v249, v231 row_newbcast:11 row_mask:0xf bank_mask:0xf
v_mul_f32_dpp v230, v249, v230 row_newbcast:2 row_mask:0xf bank_mask:0xf
v_mul_f32_dpp v231, v249, v231 row_newbcast:3 row_mask:0xf bank_mask:0xf
v_cvt_pk_bf16_f32 v28, v228, v229
v_cvt_pk_bf16_f32 v29, v230, v231
global_load_dwordx4 a[56:59], v2, s[38:39] offset:2048
v_lshlrev_b32 v228, 16, v30
v_and_b32 v229, s52, v30
v_lshlrev_b32 v230, 16, v31
v_and_b32 v231, s52, v31
v_fmac_f32_dpp v238, v249, v228 row_newbcast:12 row_mask:0xf bank_mask:0xf
v_fmac_f32_dpp v239, v249, v229 row_newbcast:13 row_mask:0xf bank_mask:0xf
v_mul_f32_dpp v228, v249, v228 row_newbcast:4 row_mask:0xf bank_mask:0xf
v_mul_f32_dpp v229, v249, v229 row_newbcast:5 row_mask:0xf bank_mask:0xf
v_fmac_f32_dpp v238, v249, v230 row_newbcast:14 row_mask:0xf bank_mask:0xf
v_fmac_f32_dpp v239, v249, v231 row_newbcast:15 row_mask:0xf bank_mask:0xf
v_mul_f32_dpp v230, v249, v230 row_newbcast:6 row_mask:0xf bank_mask:0xf
v_mul_f32_dpp v231, v249, v231 row_newbcast:7 row_mask:0xf bank_mask:0xf
v_cvt_pk_bf16_f32 v30, v228, v229
v_cvt_pk_bf16_f32 v31, v230, v231
ds_write_b128 v11, v[28:31] offset:1024
global_load_dwordx4 a[60:63], v2, s[38:39] offset:3072
v_lshlrev_b32 v228, 16, v36
v_and_b32 v229, s52, v36
v_lshlrev_b32 v230, 16, v37
v_and_b32 v231, s52, v37
v_fmac_f32_dpp v240, v249, v228 row_newbcast:8 row_mask:0xf bank_mask:0xf
v_fmac_f32_dpp v241, v249, v229 row_newbcast:9 row_mask:0xf bank_mask:0xf
v_mul_f32_dpp v228, v249, v228 row_newbcast:0 row_mask:0xf bank_mask:0xf
v_mul_f32_dpp v229, v249, v229 row_newbcast:1 row_mask:0xf bank_mask:0xf
v_fmac_f32_dpp v240, v249, v230 row_newbcast:10 row_mask:0xf bank_mask:0xf
v_fmac_f32_dpp v241, v249, v231 row_newbcast:11 row_mask:0xf bank_mask:0xf
v_mul_f32_dpp v230, v249, v230 row_newbcast:2 row_mask:0xf bank_mask:0xf
v_mul_f32_dpp v231, v249, v231 row_newbcast:3 row_mask:0xf bank_mask:0xf
v_cvt_pk_bf16_f32 v36, v228, v229
v_cvt_pk_bf16_f32 v37, v230, v231
v_lshlrev_b32 v228, 16, v38
v_and_b32 v229, s52, v38
v_lshlrev_b32 v230, 16, v39
v_and_b32 v231, s52, v39
v_fmac_f32_dpp v240, v249, v228 row_newbcast:12 row_mask:0xf bank_mask:0xf
v_fmac_f32_dpp v241, v249, v229 row_newbcast:13 row_mask:0xf bank_mask:0xf
v_mul_f32_dpp v228, v249, v228 row_newbcast:4 row_mask:0xf bank_mask:0xf
v_mul_f32_dpp v229, v249, v229 row_newbcast:5 row_mask:0xf bank_mask:0xf
v_fmac_f32_dpp v240, v249, v230 row_newbcast:14 row_mask:0xf bank_mask:0xf
v_fmac_f32_dpp v241, v249, v231 row_newbcast:15 row_mask:0xf bank_mask:0xf
v_mul_f32_dpp v230, v249, v230 row_newbcast:6 row_mask:0xf bank_mask:0xf
v_mul_f32_dpp v231, v249, v231 row_newbcast:7 row_mask:0xf bank_mask:0xf
v_cvt_pk_bf16_f32 v38, v228, v229
v_cvt_pk_bf16_f32 v39, v230, v231
ds_write_b128 v12, v[36:39] offset:1024
s_waitcnt lgkmcnt(0)
s_barrier
ds_read_b128 v[160:163], v7 offset:0
ds_read_b128 v[164:167], v8 offset:0
ds_read_b128 v[168:171], v9 offset:0
ds_read_b128 v[172:175], v7 offset:1024
ds_read_b128 v[176:179], v8 offset:1024
ds_read_b128 v[180:183], v9 offset:1024
s_waitcnt vmcnt(14)
ds_read_b128 v[184:187], v7 offset:2048
ds_read_b128 v[188:191], v8 offset:2048
ds_read_b128 v[192:195], v9 offset:2048
s_waitcnt lgkmcnt(6)
v_mfma_f32_32x32x16_bf16 v[112:127], v[160:163], a[0:3], 0
v_lshlrev_b32 v228, 16, v40
v_and_b32 v229, s52, v40
v_lshlrev_b32 v230, 16, v41
v_and_b32 v231, s52, v41
v_fmac_f32_dpp v236, v250, v228 row_newbcast:8 row_mask:0xf bank_mask:0xf
v_fmac_f32_dpp v237, v250, v229 row_newbcast:9 row_mask:0xf bank_mask:0xf
v_mul_f32_dpp v228, v250, v228 row_newbcast:0 row_mask:0xf bank_mask:0xf
global_load_dwordx4 v[88:91], v3, s[34:35] offset:0
v_mfma_f32_32x32x16_bf16 v[128:143], v[164:167], a[0:3], 0
v_mul_f32_dpp v229, v250, v229 row_newbcast:1 row_mask:0xf bank_mask:0xf
v_fmac_f32_dpp v236, v250, v230 row_newbcast:10 row_mask:0xf bank_mask:0xf
v_fmac_f32_dpp v237, v250, v231 row_newbcast:11 row_mask:0xf bank_mask:0xf
v_mul_f32_dpp v230, v250, v230 row_newbcast:2 row_mask:0xf bank_mask:0xf
v_mul_f32_dpp v231, v250, v231 row_newbcast:3 row_mask:0xf bank_mask:0xf
v_cvt_pk_bf16_f32 v40, v228, v229
v_cvt_pk_bf16_f32 v41, v230, v231
global_load_dwordx4 v[96:99], v4, s[34:35] offset:0
v_mfma_f32_32x32x16_bf16 v[144:159], a[0:3], v[168:171], 0
v_lshlrev_b32 v228, 16, v42
v_and_b32 v229, s52, v42
v_lshlrev_b32 v230, 16, v43
v_and_b32 v231, s52, v43
v_fmac_f32_dpp v236, v250, v228 row_newbcast:12 row_mask:0xf bank_mask:0xf
v_fmac_f32_dpp v237, v250, v229 row_newbcast:13 row_mask:0xf bank_mask:0xf
v_mul_f32_dpp v228, v250, v228 row_newbcast:4 row_mask:0xf bank_mask:0xf
ds_read_b128 v[160:163], v7 offset:3072
ds_read_b128 v[164:167], v8 offset:3072
ds_read_b128 v[168:171], v9 offset:3072
s_waitcnt lgkmcnt(6)
v_mfma_f32_32x32x16_bf16 v[112:127], v[172:175], a[4:7], v[112:127]
v_mul_f32_dpp v229, v250, v229 row_newbcast:5 row_mask:0xf bank_mask:0xf
v_fmac_f32_dpp v236, v250, v230 row_newbcast:14 row_mask:0xf bank_mask:0xf
v_fmac_f32_dpp v237, v250, v231 row_newbcast:15 row_mask:0xf bank_mask:0xf
v_mul_f32_dpp v230, v250, v230 row_newbcast:6 row_mask:0xf bank_mask:0xf
v_mul_f32_dpp v231, v250, v231 row_newbcast:7 row_mask:0xf bank_mask:0xf
v_cvt_pk_bf16_f32 v42, v228, v229
v_cvt_pk_bf16_f32 v43, v230, v231
global_load_dwordx4 v[104:107], v5, s[34:35] offset:0
v_mfma_f32_32x32x16_bf16 v[128:143], v[176:179], a[4:7], v[128:143]
ds_write_b128 v10, v[40:43] offset:8192
v_lshlrev_b32 v228, 16, v48
v_and_b32 v229, s52, v48
v_lshlrev_b32 v230, 16, v49
v_and_b32 v231, s52, v49
v_fmac_f32_dpp v238, v250, v228 row_newbcast:8 row_mask:0xf bank_mask:0xf
v_fmac_f32_dpp v239, v250, v229 row_newbcast:9 row_mask:0xf bank_mask:0xf
v_mul_f32_dpp v228, v250, v228 row_newbcast:0 row_mask:0xf bank_mask:0xf
global_load_dwordx4 v[92:95], v3, s[34:35] offset:1024
v_mfma_f32_32x32x16_bf16 v[144:159], a[4:7], v[180:183], v[144:159]
v_mul_f32_dpp v229, v250, v229 row_newbcast:1 row_mask:0xf bank_mask:0xf
v_fmac_f32_dpp v238, v250, v230 row_newbcast:10 row_mask:0xf bank_mask:0xf
v_fmac_f32_dpp v239, v250, v231 row_newbcast:11 row_mask:0xf bank_mask:0xf
v_mul_f32_dpp v230, v250, v230 row_newbcast:2 row_mask:0xf bank_mask:0xf
v_mul_f32_dpp v231, v250, v231 row_newbcast:3 row_mask:0xf bank_mask:0xf
v_cvt_pk_bf16_f32 v48, v228, v229
v_cvt_pk_bf16_f32 v49, v230, v231
ds_read_b128 v[172:175], v7 offset:4096
ds_read_b128 v[176:179], v8 offset:4096
ds_read_b128 v[180:183], v9 offset:4096
s_waitcnt lgkmcnt(7)
v_mfma_f32_32x32x16_bf16 v[112:127], v[184:187], a[8:11], v[112:127]
v_lshlrev_b32 v228, 16, v50
v_and_b32 v229, s52, v50
v_lshlrev_b32 v230, 16, v51
v_and_b32 v231, s52, v51
v_fmac_f32_dpp v238, v250, v228 row_newbcast:12 row_mask:0xf bank_mask:0xf
v_fmac_f32_dpp v239, v250, v229 row_newbcast:13 row_mask:0xf bank_mask:0xf
v_mul_f32_dpp v228, v250, v228 row_newbcast:4 row_mask:0xf bank_mask:0xf
global_load_dwordx4 v[100:103], v4, s[34:35] offset:1024
v_mfma_f32_32x32x16_bf16 v[128:143], v[188:191], a[8:11], v[128:143]
v_mul_f32_dpp v229, v250, v229 row_newbcast:5 row_mask:0xf bank_mask:0xf
v_fmac_f32_dpp v238, v250, v230 row_newbcast:14 row_mask:0xf bank_mask:0xf
v_fmac_f32_dpp v239, v250, v231 row_newbcast:15 row_mask:0xf bank_mask:0xf
v_mul_f32_dpp v230, v250, v230 row_newbcast:6 row_mask:0xf bank_mask:0xf
v_mul_f32_dpp v231, v250, v231 row_newbcast:7 row_mask:0xf bank_mask:0xf
v_cvt_pk_bf16_f32 v50, v228, v229
v_cvt_pk_bf16_f32 v51, v230, v231
global_load_dwordx4 v[108:111], v5, s[34:35] offset:1024
v_mfma_f32_32x32x16_bf16 v[144:159], a[8:11], v[192:195], v[144:159]
ds_write_b128 v11, v[48:51] offset:8192
v_lshlrev_b32 v228, 16, v56
v_and_b32 v229, s52, v56
v_lshlrev_b32 v230, 16, v57
v_and_b32 v231, s52, v57
v_fmac_f32_dpp v240, v250, v228 row_newbcast:8 row_mask:0xf bank_mask:0xf
v_fmac_f32_dpp v241, v250, v229 row_newbcast:9 row_mask:0xf bank_mask:0xf
v_mul_f32_dpp v228, v250, v228 row_newbcast:0 row_mask:0xf bank_mask:0xf
ds_read_b128 v[184:187], v7 offset:5120
ds_read_b128 v[188:191], v8 offset:5120
ds_read_b128 v[192:195], v9 offset:5120
s_waitcnt lgkmcnt(8)
v_mfma_f32_32x32x16_bf16 v[112:127], v[160:163], a[12:15], v[112:127]
v_mul_f32_dpp v229, v250, v229 row_newbcast:1 row_mask:0xf bank_mask:0xf
v_fmac_f32_dpp v240, v250, v230 row_newbcast:10 row_mask:0xf bank_mask:0xf
v_fmac_f32_dpp v241, v250, v231 row_newbcast:11 row_mask:0xf bank_mask:0xf
v_mul_f32_dpp v230, v250, v230 row_newbcast:2 row_mask:0xf bank_mask:0xf
v_mul_f32_dpp v231, v250, v231 row_newbcast:3 row_mask:0xf bank_mask:0xf
v_cvt_pk_bf16_f32 v56, v228, v229
v_cvt_pk_bf16_f32 v57, v230, v231
global_load_dwordx4 a[64:67], v2, s[40:41] offset:-4096
v_mfma_f32_32x32x16_bf16 v[128:143], v[164:167], a[12:15], v[128:143]
v_lshlrev_b32 v228, 16, v58
v_and_b32 v229, s52, v58
v_lshlrev_b32 v230, 16, v59
v_and_b32 v231, s52, v59
v_fmac_f32_dpp v240, v250, v228 row_newbcast:12 row_mask:0xf bank_mask:0xf
v_fmac_f32_dpp v241, v250, v229 row_newbcast:13 row_mask:0xf bank_mask:0xf
v_mul_f32_dpp v228, v250, v228 row_newbcast:4 row_mask:0xf bank_mask:0xf
global_load_dwordx4 a[68:71], v2, s[40:41] offset:-3072
v_mfma_f32_32x32x16_bf16 v[144:159], a[12:15], v[168:171], v[144:159]
v_mul_f32_dpp v229, v250, v229 row_newbcast:5 row_mask:0xf bank_mask:0xf
v_fmac_f32_dpp v240, v250, v230 row_newbcast:14 row_mask:0xf bank_mask:0xf
v_fmac_f32_dpp v241, v250, v231 row_newbcast:15 row_mask:0xf bank_mask:0xf
v_mul_f32_dpp v230, v250, v230 row_newbcast:6 row_mask:0xf bank_mask:0xf
v_mul_f32_dpp v231, v250, v231 row_newbcast:7 row_mask:0xf bank_mask:0xf
v_cvt_pk_bf16_f32 v58, v228, v229
v_cvt_pk_bf16_f32 v59, v230, v231
ds_read_b128 v[160:163], v7 offset:6144
ds_read_b128 v[164:167], v8 offset:6144
ds_read_b128 v[168:171], v9 offset:6144
s_waitcnt lgkmcnt(7)
v_mfma_f32_32x32x16_bf16 v[112:127], v[172:175], a[16:19], v[112:127]
ds_write_b128 v12, v[56:59] offset:8192
v_lshlrev_b32 v228, 16, v44
v_and_b32 v229, s52, v44
v_lshlrev_b32 v230, 16, v45
v_and_b32 v231, s52, v45
v_fmac_f32_dpp v236, v251, v228 row_newbcast:8 row_mask:0xf bank_mask:0xf
v_fmac_f32_dpp v237, v251, v229 row_newbcast:9 row_mask:0xf bank_mask:0xf
v_mul_f32_dpp v228, v251, v228 row_newbcast:0 row_mask:0xf bank_mask:0xf
global_load_dwordx4 a[72:75], v2, s[40:41] offset:-2048
v_mfma_f32_32x32x16_bf16 v[128:143], v[176:179], a[16:19], v[128:143]
v_mul_f32_dpp v229, v251, v229 row_newbcast:1 row_mask:0xf bank_mask:0xf
v_fmac_f32_dpp v236, v251, v230 row_newbcast:10 row_mask:0xf bank_mask:0xf
v_fmac_f32_dpp v237, v251, v231 row_newbcast:11 row_mask:0xf bank_mask:0xf
v_mul_f32_dpp v230, v251, v230 row_newbcast:2 row_mask:0xf bank_mask:0xf
v_mul_f32_dpp v231, v251, v231 row_newbcast:3 row_mask:0xf bank_mask:0xf
v_cvt_pk_bf16_f32 v44, v228, v229
v_cvt_pk_bf16_f32 v45, v230, v231
global_load_dwordx4 a[76:79], v2, s[40:41] offset:-1024
v_mfma_f32_32x32x16_bf16 v[144:159], a[16:19], v[180:183], v[144:159]
v_lshlrev_b32 v228, 16, v46
v_and_b32 v229, s52, v46
v_lshlrev_b32 v230, 16, v47
v_and_b32 v231, s52, v47
v_fmac_f32_dpp v236, v251, v228 row_newbcast:12 row_mask:0xf bank_mask:0xf
v_fmac_f32_dpp v237, v251, v229 row_newbcast:13 row_mask:0xf bank_mask:0xf
v_mul_f32_dpp v228, v251, v228 row_newbcast:4 row_mask:0xf bank_mask:0xf
ds_read_b128 v[172:175], v7 offset:7168
ds_read_b128 v[176:179], v8 offset:7168
ds_read_b128 v[180:183], v9 offset:7168
s_waitcnt lgkmcnt(7)
v_mfma_f32_32x32x16_bf16 v[112:127], v[184:187], a[20:23], v[112:127]
v_mul_f32_dpp v229, v251, v229 row_newbcast:5 row_mask:0xf bank_mask:0xf
v_fmac_f32_dpp v236, v251, v230 row_newbcast:14 row_mask:0xf bank_mask:0xf
v_fmac_f32_dpp v237, v251, v231 row_newbcast:15 row_mask:0xf bank_mask:0xf
v_mul_f32_dpp v230, v251, v230 row_newbcast:6 row_mask:0xf bank_mask:0xf
v_mul_f32_dpp v231, v251, v231 row_newbcast:7 row_mask:0xf bank_mask:0xf
v_cvt_pk_bf16_f32 v46, v228, v229
v_cvt_pk_bf16_f32 v47, v230, v231
global_load_dwordx4 a[80:83], v2, s[40:41] offset:0
v_mfma_f32_32x32x16_bf16 v[128:143], v[188:191], a[20:23], v[128:143]
ds_write_b128 v10, v[44:47] offset:9216
v_lshlrev_b32 v228, 16, v52
v_and_b32 v229, s52, v52
v_lshlrev_b32 v230, 16, v53
v_and_b32 v231, s52, v53
v_fmac_f32_dpp v238, v251, v228 row_newbcast:8 row_mask:0xf bank_mask:0xf
v_fmac_f32_dpp v239, v251, v229 row_newbcast:9 row_mask:0xf bank_mask:0xf
v_mul_f32_dpp v228, v251, v228 row_newbcast:0 row_mask:0xf bank_mask:0xf
global_load_dwordx4 a[84:87], v2, s[40:41] offset:1024
v_mfma_f32_32x32x16_bf16 v[144:159], a[20:23], v[192:195], v[144:159]
v_mul_f32_dpp v229, v251, v229 row_newbcast:1 row_mask:0xf bank_mask:0xf
v_fmac_f32_dpp v238, v251, v230 row_newbcast:10 row_mask:0xf bank_mask:0xf
v_fmac_f32_dpp v239, v251, v231 row_newbcast:11 row_mask:0xf bank_mask:0xf
v_mul_f32_dpp v230, v251, v230 row_newbcast:2 row_mask:0xf bank_mask:0xf
v_mul_f32_dpp v231, v251, v231 row_newbcast:3 row_mask:0xf bank_mask:0xf
v_cvt_pk_bf16_f32 v52, v228, v229
v_cvt_pk_bf16_f32 v53, v230, v231
s_waitcnt lgkmcnt(5)
v_mfma_f32_32x32x16_bf16 v[112:127], v[160:163], a[24:27], v[112:127]
v_lshlrev_b32 v228, 16, v54
v_and_b32 v229, s52, v54
v_lshlrev_b32 v230, 16, v55
v_and_b32 v231, s52, v55
v_fmac_f32_dpp v238, v251, v228 row_newbcast:12 row_mask:0xf bank_mask:0xf
v_fmac_f32_dpp v239, v251, v229 row_newbcast:13 row_mask:0xf bank_mask:0xf
v_mul_f32_dpp v228, v251, v228 row_newbcast:4 row_mask:0xf bank_mask:0xf
global_load_dwordx4 a[88:91], v2, s[40:41] offset:2048
v_mfma_f32_32x32x16_bf16 v[128:143], v[164:167], a[24:27], v[128:143]
v_mul_f32_dpp v229, v251, v229 row_newbcast:5 row_mask:0xf bank_mask:0xf
v_fmac_f32_dpp v238, v251, v230 row_newbcast:14 row_mask:0xf bank_mask:0xf
v_fmac_f32_dpp v239, v251, v231 row_newbcast:15 row_mask:0xf bank_mask:0xf
v_mul_f32_dpp v230, v251, v230 row_newbcast:6 row_mask:0xf bank_mask:0xf
v_mul_f32_dpp v231, v251, v231 row_newbcast:7 row_mask:0xf bank_mask:0xf
v_cvt_pk_bf16_f32 v54, v228, v229
v_cvt_pk_bf16_f32 v55, v230, v231
global_load_dwordx4 a[92:95], v2, s[40:41] offset:3072
v_mfma_f32_32x32x16_bf16 v[144:159], a[24:27], v[168:171], v[144:159]
ds_write_b128 v11, v[52:55] offset:9216
v_lshlrev_b32 v228, 16, v60
v_and_b32 v229, s52, v60
v_lshlrev_b32 v230, 16, v61
v_and_b32 v231, s52, v61
v_fmac_f32_dpp v240, v251, v228 row_newbcast:8 row_mask:0xf bank_mask:0xf
v_fmac_f32_dpp v241, v251, v229 row_newbcast:9 row_mask:0xf bank_mask:0xf
v_mul_f32_dpp v228, v251, v228 row_newbcast:0 row_mask:0xf bank_mask:0xf
s_waitcnt lgkmcnt(2)
v_mfma_f32_32x32x16_bf16 v[112:127], v[172:175], a[28:31], v[112:127]
v_mul_f32_dpp v229, v251, v229 row_newbcast:1 row_mask:0xf bank_mask:0xf
v_fmac_f32_dpp v240, v251, v230 row_newbcast:10 row_mask:0xf bank_mask:0xf
v_fmac_f32_dpp v241, v251, v231 row_newbcast:11 row_mask:0xf bank_mask:0xf
v_mul_f32_dpp v230, v251, v230 row_newbcast:2 row_mask:0xf bank_mask:0xf
v_mul_f32_dpp v231, v251, v231 row_newbcast:3 row_mask:0xf bank_mask:0xf
v_cvt_pk_bf16_f32 v60, v228, v229
v_cvt_pk_bf16_f32 v61, v230, v231
v_mfma_f32_32x32x16_bf16 v[128:143], v[176:179], a[28:31], v[128:143]
v_lshlrev_b32 v228, 16, v62
v_and_b32 v229, s52, v62
v_lshlrev_b32 v230, 16, v63
v_and_b32 v231, s52, v63
v_fmac_f32_dpp v240, v251, v228 row_newbcast:12 row_mask:0xf bank_mask:0xf
v_fmac_f32_dpp v241, v251, v229 row_newbcast:13 row_mask:0xf bank_mask:0xf
v_mul_f32_dpp v228, v251, v228 row_newbcast:4 row_mask:0xf bank_mask:0xf
v_mfma_f32_32x32x16_bf16 v[144:159], a[28:31], v[180:183], v[144:159]
v_mul_f32_dpp v229, v251, v229 row_newbcast:5 row_mask:0xf bank_mask:0xf
v_fmac_f32_dpp v240, v251, v230 row_newbcast:14 row_mask:0xf bank_mask:0xf
v_fmac_f32_dpp v241, v251, v231 row_newbcast:15 row_mask:0xf bank_mask:0xf
v_mul_f32_dpp v230, v251, v230 row_newbcast:6 row_mask:0xf bank_mask:0xf
v_mul_f32_dpp v231, v251, v231 row_newbcast:7 row_mask:0xf bank_mask:0xf
v_cvt_pk_bf16_f32 v62, v228, v229
v_cvt_pk_bf16_f32 v63, v230, v231
ds_write_b128 v12, v[60:63] offset:9216
s_waitcnt lgkmcnt(0)
s_barrier
ds_read_b128 v[160:163], v7 offset:8192
ds_read_b128 v[164:167], v8 offset:8192
ds_read_b128 v[168:171], v9 offset:8192
ds_read_b128 v[172:175], v7 offset:9216
ds_read_b128 v[176:179], v8 offset:9216
ds_read_b128 v[180:183], v9 offset:9216
s_waitcnt vmcnt(14)
ds_read_b128 v[184:187], v7 offset:10240
ds_read_b128 v[188:191], v8 offset:10240
ds_read_b128 v[192:195], v9 offset:10240
s_waitcnt lgkmcnt(6)
v_mfma_f32_32x32x16_bf16 v[112:127], v[160:163], a[32:35], v[112:127]
v_lshlrev_b32 v228, 16, v64
v_and_b32 v229, s52, v64
v_lshlrev_b32 v230, 16, v65
v_and_b32 v231, s52, v65
v_fmac_f32_dpp v236, v252, v228 row_newbcast:8 row_mask:0xf bank_mask:0xf
v_fmac_f32_dpp v237, v252, v229 row_newbcast:9 row_mask:0xf bank_mask:0xf
v_mul_f32_dpp v228, v252, v228 row_newbcast:0 row_mask:0xf bank_mask:0xf
global_load_dwordx4 a[96:99], v2, s[42:43] offset:-4096
v_mfma_f32_32x32x16_bf16 v[128:143], v[164:167], a[32:35], v[128:143]
v_mul_f32_dpp v229, v252, v229 row_newbcast:1 row_mask:0xf bank_mask:0xf
v_fmac_f32_dpp v236, v252, v230 row_newbcast:10 row_mask:0xf bank_mask:0xf
v_fmac_f32_dpp v237, v252, v231 row_newbcast:11 row_mask:0xf bank_mask:0xf
v_mul_f32_dpp v230, v252, v230 row_newbcast:2 row_mask:0xf bank_mask:0xf
v_mul_f32_dpp v231, v252, v231 row_newbcast:3 row_mask:0xf bank_mask:0xf
v_cvt_pk_bf16_f32 v64, v228, v229
v_cvt_pk_bf16_f32 v65, v230, v231
global_load_dwordx4 a[100:103], v2, s[42:43] offset:-3072
v_mfma_f32_32x32x16_bf16 v[144:159], a[32:35], v[168:171], v[144:159]
v_lshlrev_b32 v228, 16, v66
v_and_b32 v229, s52, v66
v_lshlrev_b32 v230, 16, v67
v_and_b32 v231, s52, v67
v_fmac_f32_dpp v236, v252, v228 row_newbcast:12 row_mask:0xf bank_mask:0xf
v_fmac_f32_dpp v237, v252, v229 row_newbcast:13 row_mask:0xf bank_mask:0xf
v_mul_f32_dpp v228, v252, v228 row_newbcast:4 row_mask:0xf bank_mask:0xf
ds_read_b128 v[160:163], v7 offset:11264
ds_read_b128 v[164:167], v8 offset:11264
ds_read_b128 v[168:171], v9 offset:11264
s_waitcnt lgkmcnt(6)
v_mfma_f32_32x32x16_bf16 v[112:127], v[172:175], a[36:39], v[112:127]
v_mul_f32_dpp v229, v252, v229 row_newbcast:5 row_mask:0xf bank_mask:0xf
v_fmac_f32_dpp v236, v252, v230 row_newbcast:14 row_mask:0xf bank_mask:0xf
v_fmac_f32_dpp v237, v252, v231 row_newbcast:15 row_mask:0xf bank_mask:0xf
v_mul_f32_dpp v230, v252, v230 row_newbcast:6 row_mask:0xf bank_mask:0xf
v_mul_f32_dpp v231, v252, v231 row_newbcast:7 row_mask:0xf bank_mask:0xf
v_cvt_pk_bf16_f32 v66, v228, v229
v_cvt_pk_bf16_f32 v67, v230, v231
global_load_dwordx4 a[104:107], v2, s[42:43] offset:-2048
v_mfma_f32_32x32x16_bf16 v[128:143], v[176:179], a[36:39], v[128:143]
ds_write_b128 v10, v[64:67] offset:16384
v_lshlrev_b32 v228, 16, v72
v_and_b32 v229, s52, v72
v_lshlrev_b32 v230, 16, v73
v_and_b32 v231, s52, v73
v_fmac_f32_dpp v238, v252, v228 row_newbcast:8 row_mask:0xf bank_mask:0xf
v_fmac_f32_dpp v239, v252, v229 row_newbcast:9 row_mask:0xf bank_mask:0xf
v_mul_f32_dpp v228, v252, v228 row_newbcast:0 row_mask:0xf bank_mask:0xf
global_load_dwordx4 a[108:111], v2, s[42:43] offset:-1024
v_mfma_f32_32x32x16_bf16 v[144:159], a[36:39], v[180:183], v[144:159]
v_mul_f32_dpp v229, v252, v229 row_newbcast:1 row_mask:0xf bank_mask:0xf
v_fmac_f32_dpp v238, v252, v230 row_newbcast:10 row_mask:0xf bank_mask:0xf
v_fmac_f32_dpp v239, v252, v231 row_newbcast:11 row_mask:0xf bank_mask:0xf
v_mul_f32_dpp v230, v252, v230 row_newbcast:2 row_mask:0xf bank_mask:0xf
v_mul_f32_dpp v231, v252, v231 row_newbcast:3 row_mask:0xf bank_mask:0xf
v_cvt_pk_bf16_f32 v72, v228, v229
v_cvt_pk_bf16_f32 v73, v230, v231
ds_read_b128 v[172:175], v7 offset:12288
ds_read_b128 v[176:179], v8 offset:12288
ds_read_b128 v[180:183], v9 offset:12288
s_waitcnt lgkmcnt(7)
v_mfma_f32_32x32x16_bf16 v[112:127], v[184:187], a[40:43], v[112:127]
v_lshlrev_b32 v228, 16, v74
v_and_b32 v229, s52, v74
v_lshlrev_b32 v230, 16, v75
v_and_b32 v231, s52, v75
v_fmac_f32_dpp v238, v252, v228 row_newbcast:12 row_mask:0xf bank_mask:0xf
v_fmac_f32_dpp v239, v252, v229 row_newbcast:13 row_mask:0xf bank_mask:0xf
v_mul_f32_dpp v228, v252, v228 row_newbcast:4 row_mask:0xf bank_mask:0xf
global_load_dwordx4 a[112:115], v2, s[42:43] offset:0
v_mfma_f32_32x32x16_bf16 v[128:143], v[188:191], a[40:43], v[128:143]
v_mul_f32_dpp v229, v252, v229 row_newbcast:5 row_mask:0xf bank_mask:0xf
v_fmac_f32_dpp v238, v252, v230 row_newbcast:14 row_mask:0xf bank_mask:0xf
v_fmac_f32_dpp v239, v252, v231 row_newbcast:15 row_mask:0xf bank_mask:0xf
v_mul_f32_dpp v230, v252, v230 row_newbcast:6 row_mask:0xf bank_mask:0xf
v_mul_f32_dpp v231, v252, v231 row_newbcast:7 row_mask:0xf bank_mask:0xf
v_cvt_pk_bf16_f32 v74, v228, v229
v_cvt_pk_bf16_f32 v75, v230, v231
global_load_dwordx4 a[116:119], v2, s[42:43] offset:1024
v_mfma_f32_32x32x16_bf16 v[144:159], a[40:43], v[192:195], v[144:159]
ds_write_b128 v11, v[72:75] offset:16384
v_lshlrev_b32 v228, 16, v80
v_and_b32 v229, s52, v80
v_lshlrev_b32 v230, 16, v81
v_and_b32 v231, s52, v81
v_fmac_f32_dpp v240, v252, v228 row_newbcast:8 row_mask:0xf bank_mask:0xf
v_fmac_f32_dpp v241, v252, v229 row_newbcast:9 row_mask:0xf bank_mask:0xf
v_mul_f32_dpp v228, v252, v228 row_newbcast:0 row_mask:0xf bank_mask:0xf
ds_read_b128 v[184:187], v7 offset:13312
ds_read_b128 v[188:191], v8 offset:13312
ds_read_b128 v[192:195], v9 offset:13312
s_waitcnt lgkmcnt(8)
v_mfma_f32_32x32x16_bf16 v[112:127], v[160:163], a[44:47], v[112:127]
v_mul_f32_dpp v229, v252, v229 row_newbcast:1 row_mask:0xf bank_mask:0xf
v_fmac_f32_dpp v240, v252, v230 row_newbcast:10 row_mask:0xf bank_mask:0xf
v_fmac_f32_dpp v241, v252, v231 row_newbcast:11 row_mask:0xf bank_mask:0xf
v_mul_f32_dpp v230, v252, v230 row_newbcast:2 row_mask:0xf bank_mask:0xf
v_mul_f32_dpp v231, v252, v231 row_newbcast:3 row_mask:0xf bank_mask:0xf
v_cvt_pk_bf16_f32 v80, v228, v229
v_cvt_pk_bf16_f32 v81, v230, v231
global_load_dwordx4 a[120:123], v2, s[42:43] offset:2048
v_mfma_f32_32x32x16_bf16 v[128:143], v[164:167], a[44:47], v[128:143]
v_lshlrev_b32 v228, 16, v82
v_and_b32 v229, s52, v82
v_lshlrev_b32 v230, 16, v83
v_and_b32 v231, s52, v83
v_fmac_f32_dpp v240, v252, v228 row_newbcast:12 row_mask:0xf bank_mask:0xf
v_fmac_f32_dpp v241, v252, v229 row_newbcast:13 row_mask:0xf bank_mask:0xf
v_mul_f32_dpp v228, v252, v228 row_newbcast:4 row_mask:0xf bank_mask:0xf
global_load_dwordx4 a[124:127], v2, s[42:43] offset:3072
v_mfma_f32_32x32x16_bf16 v[144:159], a[44:47], v[168:171], v[144:159]
v_mul_f32_dpp v229, v252, v229 row_newbcast:5 row_mask:0xf bank_mask:0xf
v_fmac_f32_dpp v240, v252, v230 row_newbcast:14 row_mask:0xf bank_mask:0xf
v_fmac_f32_dpp v241, v252, v231 row_newbcast:15 row_mask:0xf bank_mask:0xf
v_mul_f32_dpp v230, v252, v230 row_newbcast:6 row_mask:0xf bank_mask:0xf
v_mul_f32_dpp v231, v252, v231 row_newbcast:7 row_mask:0xf bank_mask:0xf
v_cvt_pk_bf16_f32 v82, v228, v229
v_cvt_pk_bf16_f32 v83, v230, v231
ds_read_b128 v[160:163], v7 offset:14336
ds_read_b128 v[164:167], v8 offset:14336
ds_read_b128 v[168:171], v9 offset:14336
s_waitcnt lgkmcnt(7)
v_mfma_f32_32x32x16_bf16 v[112:127], v[172:175], a[48:51], v[112:127]
ds_write_b128 v12, v[80:83] offset:16384
v_lshlrev_b32 v228, 16, v68
v_and_b32 v229, s52, v68
v_lshlrev_b32 v230, 16, v69
v_and_b32 v231, s52, v69
v_fmac_f32_dpp v236, v253, v228 row_newbcast:8 row_mask:0xf bank_mask:0xf
v_fmac_f32_dpp v237, v253, v229 row_newbcast:9 row_mask:0xf bank_mask:0xf
v_mul_f32_dpp v228, v253, v228 row_newbcast:0 row_mask:0xf bank_mask:0xf
global_load_dword v242, v247, s[44:45]
v_mfma_f32_32x32x16_bf16 v[128:143], v[176:179], a[48:51], v[128:143]
v_mul_f32_dpp v229, v253, v229 row_newbcast:1 row_mask:0xf bank_mask:0xf
v_fmac_f32_dpp v236, v253, v230 row_newbcast:10 row_mask:0xf bank_mask:0xf
v_fmac_f32_dpp v237, v253, v231 row_newbcast:11 row_mask:0xf bank_mask:0xf
v_mul_f32_dpp v230, v253, v230 row_newbcast:2 row_mask:0xf bank_mask:0xf
v_mul_f32_dpp v231, v253, v231 row_newbcast:3 row_mask:0xf bank_mask:0xf
v_cvt_pk_bf16_f32 v68, v228, v229
v_cvt_pk_bf16_f32 v69, v230, v231
global_load_dword v243, v247, s[46:47]
v_mfma_f32_32x32x16_bf16 v[144:159], a[48:51], v[180:183], v[144:159]
v_lshlrev_b32 v228, 16, v70
v_and_b32 v229, s52, v70
v_lshlrev_b32 v230, 16, v71
v_and_b32 v231, s52, v71
v_fmac_f32_dpp v236, v253, v228 row_newbcast:12 row_mask:0xf bank_mask:0xf
v_fmac_f32_dpp v237, v253, v229 row_newbcast:13 row_mask:0xf bank_mask:0xf
v_mul_f32_dpp v228, v253, v228 row_newbcast:4 row_mask:0xf bank_mask:0xf
ds_read_b128 v[172:175], v7 offset:15360
ds_read_b128 v[176:179], v8 offset:15360
ds_read_b128 v[180:183], v9 offset:15360
s_waitcnt lgkmcnt(7)
v_mfma_f32_32x32x16_bf16 v[112:127], v[184:187], a[52:55], v[112:127]
v_mul_f32_dpp v229, v253, v229 row_newbcast:5 row_mask:0xf bank_mask:0xf
v_fmac_f32_dpp v236, v253, v230 row_newbcast:14 row_mask:0xf bank_mask:0xf
v_fmac_f32_dpp v237, v253, v231 row_newbcast:15 row_mask:0xf bank_mask:0xf
v_mul_f32_dpp v230, v253, v230 row_newbcast:6 row_mask:0xf bank_mask:0xf
v_mul_f32_dpp v231, v253, v231 row_newbcast:7 row_mask:0xf bank_mask:0xf
v_cvt_pk_bf16_f32 v70, v228, v229
v_cvt_pk_bf16_f32 v71, v230, v231
global_load_dword v244, v247, s[48:49]
v_mfma_f32_32x32x16_bf16 v[128:143], v[188:191], a[52:55], v[128:143]
ds_write_b128 v10, v[68:71] offset:17408
v_lshlrev_b32 v228, 16, v76
v_and_b32 v229, s52, v76
v_lshlrev_b32 v230, 16, v77
v_and_b32 v231, s52, v77
v_fmac_f32_dpp v238, v253, v228 row_newbcast:8 row_mask:0xf bank_mask:0xf
v_fmac_f32_dpp v239, v253, v229 row_newbcast:9 row_mask:0xf bank_mask:0xf
v_mul_f32_dpp v228, v253, v228 row_newbcast:0 row_mask:0xf bank_mask:0xf
global_load_dword v245, v247, s[50:51]
v_mfma_f32_32x32x16_bf16 v[144:159], a[52:55], v[192:195], v[144:159]
v_mul_f32_dpp v229, v253, v229 row_newbcast:1 row_mask:0xf bank_mask:0xf
v_fmac_f32_dpp v238, v253, v230 row_newbcast:10 row_mask:0xf bank_mask:0xf
v_fmac_f32_dpp v239, v253, v231 row_newbcast:11 row_mask:0xf bank_mask:0xf
v_mul_f32_dpp v230, v253, v230 row_newbcast:2 row_mask:0xf bank_mask:0xf
v_mul_f32_dpp v231, v253, v231 row_newbcast:3 row_mask:0xf bank_mask:0xf
v_cvt_pk_bf16_f32 v76, v228, v229
v_cvt_pk_bf16_f32 v77, v230, v231
s_waitcnt lgkmcnt(5)
v_mfma_f32_32x32x16_bf16 v[112:127], v[160:163], a[56:59], v[112:127]
v_lshlrev_b32 v228, 16, v78
v_and_b32 v229, s52, v78
v_lshlrev_b32 v230, 16, v79
v_and_b32 v231, s52, v79
v_fmac_f32_dpp v238, v253, v228 row_newbcast:12 row_mask:0xf bank_mask:0xf
v_fmac_f32_dpp v239, v253, v229 row_newbcast:13 row_mask:0xf bank_mask:0xf
v_mul_f32_dpp v228, v253, v228 row_newbcast:4 row_mask:0xf bank_mask:0xf
global_load_ushort v246, v6, s[26:27]
v_mfma_f32_32x32x16_bf16 v[128:143], v[164:167], a[56:59], v[128:143]
v_mul_f32_dpp v229, v253, v229 row_newbcast:5 row_mask:0xf bank_mask:0xf
v_fmac_f32_dpp v238, v253, v230 row_newbcast:14 row_mask:0xf bank_mask:0xf
v_fmac_f32_dpp v239, v253, v231 row_newbcast:15 row_mask:0xf bank_mask:0xf
v_mul_f32_dpp v230, v253, v230 row_newbcast:6 row_mask:0xf bank_mask:0xf
v_mul_f32_dpp v231, v253, v231 row_newbcast:7 row_mask:0xf bank_mask:0xf
v_cvt_pk_bf16_f32 v78, v228, v229
v_cvt_pk_bf16_f32 v79, v230, v231
v_mfma_f32_32x32x16_bf16 v[144:159], a[56:59], v[168:171], v[144:159]
ds_write_b128 v11, v[76:79] offset:17408
v_lshlrev_b32 v228, 16, v84
v_and_b32 v229, s52, v84
v_lshlrev_b32 v230, 16, v85
v_and_b32 v231, s52, v85
v_fmac_f32_dpp v240, v253, v228 row_newbcast:8 row_mask:0xf bank_mask:0xf
v_fmac_f32_dpp v241, v253, v229 row_newbcast:9 row_mask:0xf bank_mask:0xf
v_mul_f32_dpp v228, v253, v228 row_newbcast:0 row_mask:0xf bank_mask:0xf
s_waitcnt lgkmcnt(2)
v_mfma_f32_32x32x16_bf16 v[112:127], v[172:175], a[60:63], v[112:127]
v_mul_f32_dpp v229, v253, v229 row_newbcast:1 row_mask:0xf bank_mask:0xf
v_fmac_f32_dpp v240, v253, v230 row_newbcast:10 row_mask:0xf bank_mask:0xf
v_fmac_f32_dpp v241, v253, v231 row_newbcast:11 row_mask:0xf bank_mask:0xf
v_mul_f32_dpp v230, v253, v230 row_newbcast:2 row_mask:0xf bank_mask:0xf
v_mul_f32_dpp v231, v253, v231 row_newbcast:3 row_mask:0xf bank_mask:0xf
v_cvt_pk_bf16_f32 v84, v228, v229
v_cvt_pk_bf16_f32 v85, v230, v231
v_mfma_f32_32x32x16_bf16 v[128:143], v[176:179], a[60:63], v[128:143]
v_lshlrev_b32 v228, 16, v86
v_and_b32 v229, s52, v86
v_lshlrev_b32 v230, 16, v87
v_and_b32 v231, s52, v87
v_fmac_f32_dpp v240, v253, v228 row_newbcast:12 row_mask:0xf bank_mask:0xf
v_fmac_f32_dpp v241, v253, v229 row_newbcast:13 row_mask:0xf bank_mask:0xf
v_mul_f32_dpp v228, v253, v228 row_newbcast:4 row_mask:0xf bank_mask:0xf
v_mfma_f32_32x32x16_bf16 v[144:159], a[60:63], v[180:183], v[144:159]
v_mul_f32_dpp v229, v253, v229 row_newbcast:5 row_mask:0xf bank_mask:0xf
v_fmac_f32_dpp v240, v253, v230 row_newbcast:14 row_mask:0xf bank_mask:0xf
v_fmac_f32_dpp v241, v253, v231 row_newbcast:15 row_mask:0xf bank_mask:0xf
v_mul_f32_dpp v230, v253, v230 row_newbcast:6 row_mask:0xf bank_mask:0xf
v_mul_f32_dpp v231, v253, v231 row_newbcast:7 row_mask:0xf bank_mask:0xf
v_cvt_pk_bf16_f32 v86, v228, v229
v_cvt_pk_bf16_f32 v87, v230, v231
ds_write_b128 v12, v[84:87] offset:17408
s_waitcnt lgkmcnt(0)
s_barrier
ds_read_b128 v[160:163], v7 offset:16384
ds_read_b128 v[164:167], v8 offset:16384
ds_read_b128 v[168:171], v9 offset:16384
ds_read_b128 v[172:175], v7 offset:17408
ds_read_b128 v[176:179], v8 offset:17408
ds_read_b128 v[180:183], v9 offset:17408
s_waitcnt vmcnt(13)
ds_read_b128 v[184:187], v7 offset:18432
ds_read_b128 v[188:191], v8 offset:18432
ds_read_b128 v[192:195], v9 offset:18432
s_waitcnt lgkmcnt(6)
v_mfma_f32_32x32x16_bf16 v[112:127], v[160:163], a[64:67], v[112:127]
v_lshlrev_b32 v228, 16, v88
v_and_b32 v229, s52, v88
v_lshlrev_b32 v230, 16, v89
v_and_b32 v231, s52, v89
v_fmac_f32_dpp v236, v254, v228 row_newbcast:8 row_mask:0xf bank_mask:0xf
v_fmac_f32_dpp v237, v254, v229 row_newbcast:9 row_mask:0xf bank_mask:0xf
v_mul_f32_dpp v228, v254, v228 row_newbcast:0 row_mask:0xf bank_mask:0xf
v_mfma_f32_32x32x16_bf16 v[128:143], v[164:167], a[64:67], v[128:143]
v_mul_f32_dpp v229, v254, v229 row_newbcast:1 row_mask:0xf bank_mask:0xf
v_fmac_f32_dpp v236, v254, v230 row_newbcast:10 row_mask:0xf bank_mask:0xf
v_fmac_f32_dpp v237, v254, v231 row_newbcast:11 row_mask:0xf bank_mask:0xf
v_mul_f32_dpp v230, v254, v230 row_newbcast:2 row_mask:0xf bank_mask:0xf
v_mul_f32_dpp v231, v254, v231 row_newbcast:3 row_mask:0xf bank_mask:0xf
v_cvt_pk_bf16_f32 v88, v228, v229
v_cvt_pk_bf16_f32 v89, v230, v231
v_mfma_f32_32x32x16_bf16 v[144:159], a[64:67], v[168:171], v[144:159]
v_lshlrev_b32 v228, 16, v90
v_and_b32 v229, s52, v90
v_lshlrev_b32 v230, 16, v91
v_and_b32 v231, s52, v91
v_fmac_f32_dpp v236, v254, v228 row_newbcast:12 row_mask:0xf bank_mask:0xf
v_fmac_f32_dpp v237, v254, v229 row_newbcast:13 row_mask:0xf bank_mask:0xf
v_mul_f32_dpp v228, v254, v228 row_newbcast:4 row_mask:0xf bank_mask:0xf
ds_read_b128 v[160:163], v7 offset:19456
ds_read_b128 v[164:167], v8 offset:19456
ds_read_b128 v[168:171], v9 offset:19456
s_waitcnt lgkmcnt(6)
v_mfma_f32_32x32x16_bf16 v[112:127], v[172:175], a[68:71], v[112:127]
v_mul_f32_dpp v229, v254, v229 row_newbcast:5 row_mask:0xf bank_mask:0xf
v_fmac_f32_dpp v236, v254, v230 row_newbcast:14 row_mask:0xf bank_mask:0xf
v_fmac_f32_dpp v237, v254, v231 row_newbcast:15 row_mask:0xf bank_mask:0xf
v_mul_f32_dpp v230, v254, v230 row_newbcast:6 row_mask:0xf bank_mask:0xf
v_mul_f32_dpp v231, v254, v231 row_newbcast:7 row_mask:0xf bank_mask:0xf
v_cvt_pk_bf16_f32 v90, v228, v229
v_cvt_pk_bf16_f32 v91, v230, v231
v_mfma_f32_32x32x16_bf16 v[128:143], v[176:179], a[68:71], v[128:143]
ds_write_b128 v10, v[88:91] offset:24576
v_lshlrev_b32 v228, 16, v96
v_and_b32 v229, s52, v96
v_lshlrev_b32 v230, 16, v97
v_and_b32 v231, s52, v97
v_fmac_f32_dpp v238, v254, v228 row_newbcast:8 row_mask:0xf bank_mask:0xf
v_fmac_f32_dpp v239, v254, v229 row_newbcast:9 row_mask:0xf bank_mask:0xf
v_mul_f32_dpp v228, v254, v228 row_newbcast:0 row_mask:0xf bank_mask:0xf
v_mfma_f32_32x32x16_bf16 v[144:159], a[68:71], v[180:183], v[144:159]
v_mul_f32_dpp v229, v254, v229 row_newbcast:1 row_mask:0xf bank_mask:0xf
v_fmac_f32_dpp v238, v254, v230 row_newbcast:10 row_mask:0xf bank_mask:0xf
v_fmac_f32_dpp v239, v254, v231 row_newbcast:11 row_mask:0xf bank_mask:0xf
v_mul_f32_dpp v230, v254, v230 row_newbcast:2 row_mask:0xf bank_mask:0xf
v_mul_f32_dpp v231, v254, v231 row_newbcast:3 row_mask:0xf bank_mask:0xf
v_cvt_pk_bf16_f32 v96, v228, v229
v_cvt_pk_bf16_f32 v97, v230, v231
ds_read_b128 v[172:175], v7 offset:20480
ds_read_b128 v[176:179], v8 offset:20480
ds_read_b128 v[180:183], v9 offset:20480
s_waitcnt lgkmcnt(7)
v_mfma_f32_32x32x16_bf16 v[112:127], v[184:187], a[72:75], v[112:127]
v_lshlrev_b32 v228, 16, v98
v_and_b32 v229, s52, v98
v_lshlrev_b32 v230, 16, v99
v_and_b32 v231, s52, v99
v_fmac_f32_dpp v238, v254, v228 row_newbcast:12 row_mask:0xf bank_mask:0xf
v_fmac_f32_dpp v239, v254, v229 row_newbcast:13 row_mask:0xf bank_mask:0xf
v_mul_f32_dpp v228, v254, v228 row_newbcast:4 row_mask:0xf bank_mask:0xf
v_mfma_f32_32x32x16_bf16 v[128:143], v[188:191], a[72:75], v[128:143]
v_mul_f32_dpp v229, v254, v229 row_newbcast:5 row_mask:0xf bank_mask:0xf
v_fmac_f32_dpp v238, v254, v230 row_newbcast:14 row_mask:0xf bank_mask:0xf
v_fmac_f32_dpp v239, v254, v231 row_newbcast:15 row_mask:0xf bank_mask:0xf
v_mul_f32_dpp v230, v254, v230 row_newbcast:6 row_mask:0xf bank_mask:0xf
v_mul_f32_dpp v231, v254, v231 row_newbcast:7 row_mask:0xf bank_mask:0xf
v_cvt_pk_bf16_f32 v98, v228, v229
v_cvt_pk_bf16_f32 v99, v230, v231
v_mfma_f32_32x32x16_bf16 v[144:159], a[72:75], v[192:195], v[144:159]
ds_write_b128 v11, v[96:99] offset:24576
v_lshlrev_b32 v228, 16, v104
v_and_b32 v229, s52, v104
v_lshlrev_b32 v230, 16, v105
v_and_b32 v231, s52, v105
v_fmac_f32_dpp v240, v254, v228 row_newbcast:8 row_mask:0xf bank_mask:0xf
v_fmac_f32_dpp v241, v254, v229 row_newbcast:9 row_mask:0xf bank_mask:0xf
v_mul_f32_dpp v228, v254, v228 row_newbcast:0 row_mask:0xf bank_mask:0xf
ds_read_b128 v[184:187], v7 offset:21504
ds_read_b128 v[188:191], v8 offset:21504
ds_read_b128 v[192:195], v9 offset:21504
s_waitcnt lgkmcnt(8)
v_mfma_f32_32x32x16_bf16 v[112:127], v[160:163], a[76:79], v[112:127]
v_mul_f32_dpp v229, v254, v229 row_newbcast:1 row_mask:0xf bank_mask:0xf
v_fmac_f32_dpp v240, v254, v230 row_newbcast:10 row_mask:0xf bank_mask:0xf
v_fmac_f32_dpp v241, v254, v231 row_newbcast:11 row_mask:0xf bank_mask:0xf
v_mul_f32_dpp v230, v254, v230 row_newbcast:2 row_mask:0xf bank_mask:0xf
v_mul_f32_dpp v231, v254, v231 row_newbcast:3 row_mask:0xf bank_mask:0xf
v_cvt_pk_bf16_f32 v104, v228, v229
v_cvt_pk_bf16_f32 v105, v230, v231
v_mfma_f32_32x32x16_bf16 v[128:143], v[164:167], a[76:79], v[128:143]
v_lshlrev_b32 v228, 16, v106
v_and_b32 v229, s52, v106
v_lshlrev_b32 v230, 16, v107
v_and_b32 v231, s52, v107
v_fmac_f32_dpp v240, v254, v228 row_newbcast:12 row_mask:0xf bank_mask:0xf
v_fmac_f32_dpp v241, v254, v229 row_newbcast:13 row_mask:0xf bank_mask:0xf
v_mul_f32_dpp v228, v254, v228 row_newbcast:4 row_mask:0xf bank_mask:0xf
v_mfma_f32_32x32x16_bf16 v[144:159], a[76:79], v[168:171], v[144:159]
v_mul_f32_dpp v229, v254, v229 row_newbcast:5 row_mask:0xf bank_mask:0xf
v_fmac_f32_dpp v240, v254, v230 row_newbcast:14 row_mask:0xf bank_mask:0xf
v_fmac_f32_dpp v241, v254, v231 row_newbcast:15 row_mask:0xf bank_mask:0xf
v_mul_f32_dpp v230, v254, v230 row_newbcast:6 row_mask:0xf bank_mask:0xf
v_mul_f32_dpp v231, v254, v231 row_newbcast:7 row_mask:0xf bank_mask:0xf
v_cvt_pk_bf16_f32 v106, v228, v229
v_cvt_pk_bf16_f32 v107, v230, v231
ds_read_b128 v[160:163], v7 offset:22528
ds_read_b128 v[164:167], v8 offset:22528
ds_read_b128 v[168:171], v9 offset:22528
s_waitcnt lgkmcnt(7)
v_mfma_f32_32x32x16_bf16 v[112:127], v[172:175], a[80:83], v[112:127]
ds_write_b128 v12, v[104:107] offset:24576
v_lshlrev_b32 v228, 16, v92
v_and_b32 v229, s52, v92
v_lshlrev_b32 v230, 16, v93
v_and_b32 v231, s52, v93
v_fmac_f32_dpp v236, v255, v228 row_newbcast:8 row_mask:0xf bank_mask:0xf
v_fmac_f32_dpp v237, v255, v229 row_newbcast:9 row_mask:0xf bank_mask:0xf
v_mul_f32_dpp v228, v255, v228 row_newbcast:0 row_mask:0xf bank_mask:0xf
v_mfma_f32_32x32x16_bf16 v[128:143], v[176:179], a[80:83], v[128:143]
v_mul_f32_dpp v229, v255, v229 row_newbcast:1 row_mask:0xf bank_mask:0xf
v_fmac_f32_dpp v236, v255, v230 row_newbcast:10 row_mask:0xf bank_mask:0xf
v_fmac_f32_dpp v237, v255, v231 row_newbcast:11 row_mask:0xf bank_mask:0xf
v_mul_f32_dpp v230, v255, v230 row_newbcast:2 row_mask:0xf bank_mask:0xf
v_mul_f32_dpp v231, v255, v231 row_newbcast:3 row_mask:0xf bank_mask:0xf
v_cvt_pk_bf16_f32 v92, v228, v229
v_cvt_pk_bf16_f32 v93, v230, v231
v_mfma_f32_32x32x16_bf16 v[144:159], a[80:83], v[180:183], v[144:159]
v_lshlrev_b32 v228, 16, v94
v_and_b32 v229, s52, v94
v_lshlrev_b32 v230, 16, v95
v_and_b32 v231, s52, v95
v_fmac_f32_dpp v236, v255, v228 row_newbcast:12 row_mask:0xf bank_mask:0xf
v_fmac_f32_dpp v237, v255, v229 row_newbcast:13 row_mask:0xf bank_mask:0xf
v_mul_f32_dpp v228, v255, v228 row_newbcast:4 row_mask:0xf bank_mask:0xf
ds_read_b128 v[172:175], v7 offset:23552
ds_read_b128 v[176:179], v8 offset:23552
ds_read_b128 v[180:183], v9 offset:23552
s_waitcnt lgkmcnt(7)
v_mfma_f32_32x32x16_bf16 v[112:127], v[184:187], a[84:87], v[112:127]
v_mul_f32_dpp v229, v255, v229 row_newbcast:5 row_mask:0xf bank_mask:0xf
v_fmac_f32_dpp v236, v255, v230 row_newbcast:14 row_mask:0xf bank_mask:0xf
v_fmac_f32_dpp v237, v255, v231 row_newbcast:15 row_mask:0xf bank_mask:0xf
v_mul_f32_dpp v230, v255, v230 row_newbcast:6 row_mask:0xf bank_mask:0xf
v_mul_f32_dpp v231, v255, v231 row_newbcast:7 row_mask:0xf bank_mask:0xf
v_cvt_pk_bf16_f32 v94, v228, v229
v_cvt_pk_bf16_f32 v95, v230, v231
v_mfma_f32_32x32x16_bf16 v[128:143], v[188:191], a[84:87], v[128:143]
ds_write_b128 v10, v[92:95] offset:25600
v_lshlrev_b32 v228, 16, v100
v_and_b32 v229, s52, v100
v_lshlrev_b32 v230, 16, v101
v_and_b32 v231, s52, v101
v_fmac_f32_dpp v238, v255, v228 row_newbcast:8 row_mask:0xf bank_mask:0xf
v_fmac_f32_dpp v239, v255, v229 row_newbcast:9 row_mask:0xf bank_mask:0xf
v_mul_f32_dpp v228, v255, v228 row_newbcast:0 row_mask:0xf bank_mask:0xf
v_mfma_f32_32x32x16_bf16 v[144:159], a[84:87], v[192:195], v[144:159]
v_mul_f32_dpp v229, v255, v229 row_newbcast:1 row_mask:0xf bank_mask:0xf
v_fmac_f32_dpp v238, v255, v230 row_newbcast:10 row_mask:0xf bank_mask:0xf
v_fmac_f32_dpp v239, v255, v231 row_newbcast:11 row_mask:0xf bank_mask:0xf
v_mul_f32_dpp v230, v255, v230 row_newbcast:2 row_mask:0xf bank_mask:0xf
v_mul_f32_dpp v231, v255, v231 row_newbcast:3 row_mask:0xf bank_mask:0xf
v_cvt_pk_bf16_f32 v100, v228, v229
v_cvt_pk_bf16_f32 v101, v230, v231
s_waitcnt lgkmcnt(5)
v_mfma_f32_32x32x16_bf16 v[112:127], v[160:163], a[88:91], v[112:127]
v_lshlrev_b32 v228, 16, v102
v_and_b32 v229, s52, v102
v_lshlrev_b32 v230, 16, v103
v_and_b32 v231, s52, v103
v_fmac_f32_dpp v238, v255, v228 row_newbcast:12 row_mask:0xf bank_mask:0xf
v_fmac_f32_dpp v239, v255, v229 row_newbcast:13 row_mask:0xf bank_mask:0xf
v_mul_f32_dpp v228, v255, v228 row_newbcast:4 row_mask:0xf bank_mask:0xf
v_mfma_f32_32x32x16_bf16 v[128:143], v[164:167], a[88:91], v[128:143]
v_mul_f32_dpp v229, v255, v229 row_newbcast:5 row_mask:0xf bank_mask:0xf
v_fmac_f32_dpp v238, v255, v230 row_newbcast:14 row_mask:0xf bank_mask:0xf
v_fmac_f32_dpp v239, v255, v231 row_newbcast:15 row_mask:0xf bank_mask:0xf
v_mul_f32_dpp v230, v255, v230 row_newbcast:6 row_mask:0xf bank_mask:0xf
v_mul_f32_dpp v231, v255, v231 row_newbcast:7 row_mask:0xf bank_mask:0xf
v_cvt_pk_bf16_f32 v102, v228, v229
v_cvt_pk_bf16_f32 v103, v230, v231
v_mfma_f32_32x32x16_bf16 v[144:159], a[88:91], v[168:171], v[144:159]
ds_write_b128 v11, v[100:103] offset:25600
v_lshlrev_b32 v228, 16, v108
v_and_b32 v229, s52, v108
v_lshlrev_b32 v230, 16, v109
v_and_b32 v231, s52, v109
v_fmac_f32_dpp v240, v255, v228 row_newbcast:8 row_mask:0xf bank_mask:0xf
v_fmac_f32_dpp v241, v255, v229 row_newbcast:9 row_mask:0xf bank_mask:0xf
v_mul_f32_dpp v228, v255, v228 row_newbcast:0 row_mask:0xf bank_mask:0xf
s_waitcnt lgkmcnt(2)
v_mfma_f32_32x32x16_bf16 v[112:127], v[172:175], a[92:95], v[112:127]
v_mul_f32_dpp v229, v255, v229 row_newbcast:1 row_mask:0xf bank_mask:0xf
v_fmac_f32_dpp v240, v255, v230 row_newbcast:10 row_mask:0xf bank_mask:0xf
v_fmac_f32_dpp v241, v255, v231 row_newbcast:11 row_mask:0xf bank_mask:0xf
v_mul_f32_dpp v230, v255, v230 row_newbcast:2 row_mask:0xf bank_mask:0xf
v_mul_f32_dpp v231, v255, v231 row_newbcast:3 row_mask:0xf bank_mask:0xf
v_cvt_pk_bf16_f32 v108, v228, v229
v_cvt_pk_bf16_f32 v109, v230, v231
v_mfma_f32_32x32x16_bf16 v[128:143], v[176:179], a[92:95], v[128:143]
v_lshlrev_b32 v228, 16, v110
v_and_b32 v229, s52, v110
v_lshlrev_b32 v230, 16, v111
v_and_b32 v231, s52, v111
v_fmac_f32_dpp v240, v255, v228 row_newbcast:12 row_mask:0xf bank_mask:0xf
v_fmac_f32_dpp v241, v255, v229 row_newbcast:13 row_mask:0xf bank_mask:0xf
v_mul_f32_dpp v228, v255, v228 row_newbcast:4 row_mask:0xf bank_mask:0xf
v_mfma_f32_32x32x16_bf16 v[144:159], a[92:95], v[180:183], v[144:159]
v_mul_f32_dpp v229, v255, v229 row_newbcast:5 row_mask:0xf bank_mask:0xf
v_fmac_f32_dpp v240, v255, v230 row_newbcast:14 row_mask:0xf bank_mask:0xf
v_fmac_f32_dpp v241, v255, v231 row_newbcast:15 row_mask:0xf bank_mask:0xf
v_mul_f32_dpp v230, v255, v230 row_newbcast:6 row_mask:0xf bank_mask:0xf
v_mul_f32_dpp v231, v255, v231 row_newbcast:7 row_mask:0xf bank_mask:0xf
v_cvt_pk_bf16_f32 v110, v228, v229
v_cvt_pk_bf16_f32 v111, v230, v231
ds_write_b128 v12, v[108:111] offset:25600
v_add_f32 v236, v236, v237
v_add_f32 v238, v238, v239
v_add_f32 v240, v240, v241
v_mov_b32 v228, v236
s_nop 1
v_permlane32_swap_b32 v236, v228
v_add_f32 v236, v236, v228
v_mov_b32 v229, v238
s_nop 1
v_permlane32_swap_b32 v238, v229
v_add_f32 v238, v238, v229
v_mov_b32 v230, v240
s_nop 1
v_permlane32_swap_b32 v240, v230
v_add_f32 v240, v240, v230
v_add_u32 v13, s53, v14
ds_write_b32 v13, v236 offset:1536
ds_write_b32 v13, v238 offset:1664
ds_write_b32 v13, v240 offset:1792
s_waitcnt lgkmcnt(0)
s_barrier
ds_read_b128 v[160:163], v7 offset:24576
ds_read_b128 v[164:167], v8 offset:24576
ds_read_b128 v[168:171], v9 offset:24576
ds_read_b128 v[172:175], v7 offset:25600
ds_read_b128 v[176:179], v8 offset:25600
ds_read_b128 v[180:183], v9 offset:25600
s_waitcnt vmcnt(5)
ds_read_b128 v[184:187], v7 offset:26624
ds_read_b128 v[188:191], v8 offset:26624
ds_read_b128 v[192:195], v9 offset:26624
s_waitcnt lgkmcnt(6)
v_mfma_f32_32x32x16_bf16 v[112:127], v[160:163], a[96:99], v[112:127]
v_mfma_f32_32x32x16_bf16 v[128:143], v[164:167], a[96:99], v[128:143]
v_mfma_f32_32x32x16_bf16 v[144:159], a[96:99], v[168:171], v[144:159]
ds_read_b128 v[160:163], v7 offset:27648
ds_read_b128 v[164:167], v8 offset:27648
ds_read_b128 v[168:171], v9 offset:27648
s_waitcnt lgkmcnt(6)
v_mfma_f32_32x32x16_bf16 v[112:127], v[172:175], a[100:103], v[112:127]
v_mfma_f32_32x32x16_bf16 v[128:143], v[176:179], a[100:103], v[128:143]
v_mfma_f32_32x32x16_bf16 v[144:159], a[100:103], v[180:183], v[144:159]
ds_read_b32 v196, v15 offset:1536
ds_read_b32 v200, v14 offset:1792
ds_read_b32 v197, v15 offset:1920
ds_read_b32 v201, v14 offset:2176
ds_read_b32 v198, v15 offset:2304
ds_read_b32 v202, v14 offset:2560
ds_read_b32 v199, v15 offset:2688
ds_read_b32 v203, v14 offset:2944
ds_read_b128 v[172:175], v7 offset:28672
ds_read_b128 v[176:179], v8 offset:28672
ds_read_b128 v[180:183], v9 offset:28672
s_waitcnt lgkmcnt(14)
v_mfma_f32_32x32x16_bf16 v[112:127], v[184:187], a[104:107], v[112:127]
v_mfma_f32_32x32x16_bf16 v[128:143], v[188:191], a[104:107], v[128:143]
v_mfma_f32_32x32x16_bf16 v[144:159], a[104:107], v[192:195], v[144:159]
ds_read_b128 v[184:187], v7 offset:29696
ds_read_b128 v[188:191], v8 offset:29696
ds_read_b128 v[192:195], v9 offset:29696
s_waitcnt lgkmcnt(14)
v_mfma_f32_32x32x16_bf16 v[112:127], v[160:163], a[108:111], v[112:127]
v_mfma_f32_32x32x16_bf16 v[128:143], v[164:167], a[108:111], v[128:143]
v_mfma_f32_32x32x16_bf16 v[144:159], a[108:111], v[168:171], v[144:159]
ds_read_b128 v[160:163], v7 offset:30720
ds_read_b128 v[164:167], v8 offset:30720
ds_read_b128 v[168:171], v9 offset:30720
s_waitcnt lgkmcnt(6)
v_mfma_f32_32x32x16_bf16 v[112:127], v[172:175], a[112:115], v[112:127]
v_mfma_f32_32x32x16_bf16 v[128:143], v[176:179], a[112:115], v[128:143]
v_mfma_f32_32x32x16_bf16 v[144:159], a[112:115], v[180:183], v[144:159]
v_add_f32 v196, v196, v197
v_add_f32 v198, v198, v199
v_add_f32 v200, v200, v201
v_add_f32 v202, v202, v203
v_add_f32 v196, v196, v198
v_add_f32 v200, v200, v202
v_add_u32 v15, s53, v15
ds_write_b32 v15, v196
ds_write_b32 v13, v200 offset:256
ds_read_b128 v[172:175], v7 offset:31744
ds_read_b128 v[176:179], v8 offset:31744
ds_read_b128 v[180:183], v9 offset:31744
s_waitcnt lgkmcnt(8)
v_mfma_f32_32x32x16_bf16 v[112:127], v[184:187], a[116:119], v[112:127]
v_mfma_f32_32x32x16_bf16 v[128:143], v[188:191], a[116:119], v[128:143]
v_mfma_f32_32x32x16_bf16 v[144:159], a[116:119], v[192:195], v[144:159]
s_waitcnt lgkmcnt(5)
v_mfma_f32_32x32x16_bf16 v[112:127], v[160:163], a[120:123], v[112:127]
v_mfma_f32_32x32x16_bf16 v[128:143], v[164:167], a[120:123], v[128:143]
v_mfma_f32_32x32x16_bf16 v[144:159], a[120:123], v[168:171], v[144:159]
s_waitcnt lgkmcnt(0)
v_mfma_f32_32x32x16_bf16 v[112:127], v[172:175], a[124:127], v[112:127]
v_mfma_f32_32x32x16_bf16 v[128:143], v[176:179], a[124:127], v[128:143]
v_mfma_f32_32x32x16_bf16 v[144:159], a[124:127], v[180:183], v[144:159]
v_lshrrev_b32 v13, 5, v1
v_lshlrev_b32 v13, 4, v13
v_add_u32 v13, 102400, v13
v_add_u32 v13, s53, v13
v_add_u32 v14, s53, v14
ds_read_b128 v[16:19], v13 offset:0
ds_read_b128 v[20:23], v13 offset:32
ds_read_b128 v[24:27], v13 offset:64
ds_read_b128 v[28:31], v13 offset:96
ds_read_b128 v[32:35], v13 offset:128
ds_read_b128 v[36:39], v13 offset:160
ds_read_b128 v[40:43], v13 offset:192
ds_read_b128 v[44:47], v13 offset:224
ds_read_b32 v48, v14 offset:256
s_mov_b32 s20, 0x3eb8aa3b
s_lshl_b32 s18, s9, 17
s_lshl_b32 s19, s11, 10
s_add_u32 s18, s18, s19
s_add_u32 s19, s18, 4194304
s_add_u32 s14, s4, s19
s_addc_u32 s15, s5, 0
s_add_u32 s19, s18, 6291456
s_add_u32 s16, s4, s19
s_addc_u32 s17, s5, 0
s_add_u32 s19, s18, 8388608
s_add_u32 s22, s4, s19
s_addc_u32 s23, s5, 0
v_add_u32 v3, 0x10000, v2
v_bfe_u32 v4, v1, 4, 1
v_lshlrev_b32 v4, 16, v4
v_lshrrev_b32 v5, 5, v1
v_lshlrev_b32 v5, 8, v5
v_add_u32 v4, v4, v5
v_and_b32 v5, 15, v1
v_lshlrev_b32 v5, 4, v5
v_add_u32 v4, v4, v5
s_waitcnt lgkmcnt(0)
v_pk_add_f32 v[112:113], v[112:113], v[16:17]
v_pk_add_f32 v[114:115], v[114:115], v[18:19]
v_pk_add_f32 v[116:117], v[116:117], v[20:21]
v_pk_add_f32 v[118:119], v[118:119], v[22:23]
v_pk_add_f32 v[120:121], v[120:121], v[24:25]
v_pk_add_f32 v[122:123], v[122:123], v[26:27]
v_pk_add_f32 v[124:125], v[124:125], v[28:29]
v_pk_add_f32 v[126:127], v[126:127], v[30:31]
v_pk_mul_f32 v[112:113], v[112:113], s[20:21] op_sel_hi:[1,0]
v_pk_mul_f32 v[114:115], v[114:115], s[20:21] op_sel_hi:[1,0]
v_pk_mul_f32 v[116:117], v[116:117], s[20:21] op_sel_hi:[1,0]
v_pk_mul_f32 v[118:119], v[118:119], s[20:21] op_sel_hi:[1,0]
v_pk_mul_f32 v[120:121], v[120:121], s[20:21] op_sel_hi:[1,0]
v_pk_mul_f32 v[122:123], v[122:123], s[20:21] op_sel_hi:[1,0]
v_pk_mul_f32 v[124:125], v[124:125], s[20:21] op_sel_hi:[1,0]
v_pk_mul_f32 v[126:127], v[126:127], s[20:21] op_sel_hi:[1,0]
v_cvt_pk_bf16_f32 v56, v112, v113
v_cvt_pk_bf16_f32 v57, v114, v115
v_cvt_pk_bf16_f32 v58, v116, v117
v_cvt_pk_bf16_f32 v59, v118, v119
v_cvt_pk_bf16_f32 v60, v120, v121
v_cvt_pk_bf16_f32 v61, v122, v123
v_cvt_pk_bf16_f32 v62, v124, v125
v_cvt_pk_bf16_f32 v63, v126, v127
global_store_dwordx4 v2, v[56:59], s[14:15]
global_store_dwordx4 v3, v[60:63], s[14:15]
v_pk_add_f32 v[128:129], v[128:129], v[32:33]
v_pk_add_f32 v[130:131], v[130:131], v[34:35]
v_pk_add_f32 v[132:133], v[132:133], v[36:37]
v_pk_add_f32 v[134:135], v[134:135], v[38:39]
v_pk_add_f32 v[136:137], v[136:137], v[40:41]
v_pk_add_f32 v[138:139], v[138:139], v[42:43]
v_pk_add_f32 v[140:141], v[140:141], v[44:45]
v_pk_add_f32 v[142:143], v[142:143], v[46:47]
v_cvt_pk_bf16_f32 v64, v128, v129
v_cvt_pk_bf16_f32 v65, v130, v131
v_cvt_pk_bf16_f32 v66, v132, v133
v_cvt_pk_bf16_f32 v67, v134, v135
v_cvt_pk_bf16_f32 v68, v136, v137
v_cvt_pk_bf16_f32 v69, v138, v139
v_cvt_pk_bf16_f32 v70, v140, v141
v_cvt_pk_bf16_f32 v71, v142, v143
global_store_dwordx4 v2, v[64:67], s[16:17]
global_store_dwordx4 v3, v[68:71], s[16:17]
v_pk_add_f32 v[144:145], v[144:145], v[48:49] op_sel_hi:[1,0]
v_pk_add_f32 v[146:147], v[146:147], v[48:49] op_sel_hi:[1,0]
v_pk_add_f32 v[148:149], v[148:149], v[48:49] op_sel_hi:[1,0]
v_pk_add_f32 v[150:151], v[150:151], v[48:49] op_sel_hi:[1,0]
v_pk_add_f32 v[152:153], v[152:153], v[48:49] op_sel_hi:[1,0]
v_pk_add_f32 v[154:155], v[154:155], v[48:49] op_sel_hi:[1,0]
v_pk_add_f32 v[156:157], v[156:157], v[48:49] op_sel_hi:[1,0]
v_pk_add_f32 v[158:159], v[158:159], v[48:49] op_sel_hi:[1,0]
v_cvt_pk_bf16_f32 v72, v144, v145
v_cvt_pk_bf16_f32 v73, v146, v147
v_cvt_pk_bf16_f32 v74, v148, v149
v_cvt_pk_bf16_f32 v75, v150, v151
v_cvt_pk_bf16_f32 v76, v152, v153
v_cvt_pk_bf16_f32 v77, v154, v155
v_cvt_pk_bf16_f32 v78, v156, v157
v_cvt_pk_bf16_f32 v79, v158, v159
global_store_dwordx4 v4, v[72:75], s[22:23]
global_store_dwordx4 v4, v[76:79], s[22:23] offset:512
s_cmp_ge_u32 s2, 8
s_cbranch_scc1 K1_END
s_waitcnt vmcnt(6)
v_add_f32 v242, v242, v243
v_add_f32 v244, v244, v245
v_add_f32 v242, v242, v244
v_cvt_pk_bf16_f32 v242, v242, v242
v_lshlrev_b32 v242, 16, v242
s_add_u32 s16, s4, 15204352
s_addc_u32 s17, s5, 0
s_lshr_b32 s14, s2, 1
s_cmp_lg_u32 s14, 2
s_cbranch_scc1 K1_FS
v_add_f32 v242, 1.0, v242
v_cvt_pk_bf16_f32 v242, v242, v242
v_lshlrev_b32 v242, 16, v242
v_lshlrev_b32 v246, 16, v246
v_mul_f32 v246, v246, v242
v_add_u32 v6, 4096, v247
global_store_dword v6, v246, s[16:17]
K1_FS:
global_store_dword v247, v242, s[16:17]
K1_END:
s_endpgm
.globl k2_kernel
.p2align 8
.type k2_kernel,@function
k2_kernel:
s_cmp_ge_u32 s2, 256
s_cbranch_scc1 K2_END
s_load_dwordx2 s[4:5], s[0:1], 96
s_load_dwordx2 s[26:27], s[0:1], 0
s_and_b32 s6, s2, 7
s_lshr_b32 s7, s2, 3
s_lshr_b32 s8, s2, 5
s_and_b32 s7, s7, 3
s_lshl_b32 s9, s6, 2
s_add_u32 s9, s9, s7
s_lshr_b32 s45, s6, 2
s_lshl_b32 s45, s45, 2
s_add_u32 s45, s45, s7
v_readfirstlane_b32 s10, v0
s_nop 3
s_lshr_b32 s10, s10, 6
v_and_b32 v1, 63, v0
v_lshlrev_b32 v2, 4, v1
s_lshl_b32 s11, s9, 6
s_lshl_b32 s12, s8, 3
s_add_u32 s11, s11, s12
s_lshl_b32 s13, s10, 1
s_add_u32 s13, s13, s11
s_lshl_b32 s13, s13, 10
s_add_u32 s14, s11, s10
s_lshl_b32 s14, s14, 10
s_waitcnt lgkmcnt(0)
s_add_u32 s15, s13, 6283264
s_add_u32 s16, s4, s15
s_addc_u32 s17, s5, 0
s_add_u32 s15, s13, 8380416
s_add_u32 s18, s4, s15
s_addc_u32 s19, s5, 0
s_add_u32 s15, s14, 4194304
s_add_u32 s20, s4, s15
s_addc_u32 s21, s5, 0
s_lshl_b32 s22, s10, 11
s_mov_b32 m0, s22
s_nop 0
global_load_lds_dwordx4 v2, s[16:17]
global_load_lds_dwordx4 v2, s[16:17] offset:1024
global_load_dwordx4 v[4:7], v2, s[20:21]
s_add_u32 m0, s22, 16384
s_nop 0
global_load_lds_dwordx4 v2, s[18:19]
global_load_lds_dwordx4 v2, s[18:19] offset:1024
v_mov_b32 v8, 0x3f803f80
v_mov_b32 v9, 0x3f803f80
v_mov_b32 v10, 0x3f803f80
v_mov_b32 v11, 0x3f803f80
v_lshlrev_b32 v3, 4, v0
ds_write_b128 v3, v[8:11] offset:32768
ds_write_b128 v3, v[8:11] offset:40960
v_and_b32 v12, 31, v1
v_lshrrev_b32 v13, 5, v1
v_lshlrev_b32 v14, 2, v13
v_sub_u32 v12, v12, v14
v_mov_b32 v14, 0xf149f2ca
v_mov_b32 v15, 0
s_sub_u32 s23, 8, s10
s_cmp_eq_u32 s8, 0
s_cselect_b32 s23, s23, 0
v_cmp_ge_i32 vcc, v12, 0
s_nop 1
v_cndmask_b32 v224, v14, v15, vcc
s_nop 0
v_cndmask_b32 v96, v15, v14, vcc
v_cmp_ge_i32 vcc, v12, 1
s_nop 1
v_cndmask_b32 v225, v14, v15, vcc
s_nop 0
v_cndmask_b32 v97, v15, v14, vcc
v_cmp_ge_i32 vcc, v12, 2
s_nop 1
v_cndmask_b32 v226, v14, v15, vcc
s_nop 0
v_cndmask_b32 v98, v15, v14, vcc
v_cmp_ge_i32 vcc, v12, 3
s_nop 1
v_cndmask_b32 v227, v14, v15, vcc
s_nop 0
v_cndmask_b32 v99, v15, v14, vcc
v_cmp_ge_i32 vcc, v12, 8
s_nop 1
v_cndmask_b32 v228, v14, v15, vcc
s_nop 0
v_cndmask_b32 v100, v15, v14, vcc
v_cmp_ge_i32 vcc, v12, 9
s_nop 1
v_cndmask_b32 v229, v14, v15, vcc
s_nop 0
v_cndmask_b32 v101, v15, v14, vcc
v_cmp_ge_i32 vcc, v12, 10
s_nop 1
v_cndmask_b32 v230, v14, v15, vcc
s_nop 0
v_cndmask_b32 v102, v15, v14, vcc
v_cmp_ge_i32 vcc, v12, 11
s_nop 1
v_cndmask_b32 v231, v14, v15, vcc
s_nop 0
v_cndmask_b32 v103, v15, v14, vcc
v_cmp_ge_i32 vcc, v12, 16
s_nop 1
v_cndmask_b32 v232, v14, v15, vcc
s_nop 0
v_cndmask_b32 v104, v15, v14, vcc
v_cmp_ge_i32 vcc, v12, 17
s_nop 1
v_cndmask_b32 v233, v14, v15, vcc
s_nop 0
v_cndmask_b32 v105, v15, v14, vcc
v_cmp_ge_i32 vcc, v12, 18
s_nop 1
v_cndmask_b32 v234, v14, v15, vcc
s_nop 0
v_cndmask_b32 v106, v15, v14, vcc
v_cmp_ge_i32 vcc, v12, 19
s_nop 1
v_cndmask_b32 v235, v14, v15, vcc
s_nop 0
v_cndmask_b32 v107, v15, v14, vcc
v_cmp_ge_i32 vcc, v12, 24
s_nop 1
v_cndmask_b32 v236, v14, v15, vcc
s_nop 0
v_cndmask_b32 v108, v15, v14, vcc
v_cmp_ge_i32 vcc, v12, 25
s_nop 1
v_cndmask_b32 v237, v14, v15, vcc
s_nop 0
v_cndmask_b32 v109, v15, v14, vcc
v_cmp_ge_i32 vcc, v12, 26
s_nop 1
v_cndmask_b32 v238, v14, v15, vcc
s_nop 0
v_cndmask_b32 v110, v15, v14, vcc
v_cmp_ge_i32 vcc, v12, 27
s_nop 1
v_cndmask_b32 v239, v14, v15, vcc
s_nop 0
v_cndmask_b32 v111, v15, v14, vcc
s_lshl_b32 s24, s10, 10
v_add_u32 v3, s24, v2
v_and_b32 v8, 15, v1
v_lshlrev_b32 v8, 4, v8
v_lshlrev_b32 v9, 8, v13
v_add_u32 v8, v8, v9
s_add_u32 s24, s24, 16384
v_add_u32 v8, s24, v8
v_mov_b32 v9, 32768
v_and_b32 v10, 16, v1
v_cmp_eq_u32 vcc, 0, v10
s_nop 1
v_cndmask_b32 v8, v9, v8, vcc
s_cmp_eq_u32 s23, 0
s_cbranch_scc1 K2_NOINV
s_cmp_le_u32 s23, 0
s_cbranch_scc1 K2_NOINV
v_mov_b32 v96, v14
v_mov_b32 v97, v14
v_mov_b32 v98, v14
v_mov_b32 v99, v14
v_mov_b32 v100, v14
v_mov_b32 v101, v14
v_mov_b32 v102, v14
v_mov_b32 v103, v14
v_mov_b32 v104, v14
v_mov_b32 v105, v14
v_mov_b32 v106, v14
v_mov_b32 v107, v14
v_mov_b32 v108, v14
v_mov_b32 v109, v14
v_mov_b32 v110, v14
v_mov_b32 v111, v14
s_cmp_le_u32 s23, 1
s_cbranch_scc1 K2_NOINV
v_mov_b32 v112, v14
v_mov_b32 v113, v14
v_mov_b32 v114, v14
v_mov_b32 v115, v14
v_mov_b32 v116, v14
v_mov_b32 v117, v14
v_mov_b32 v118, v14
v_mov_b32 v119, v14
v_mov_b32 v120, v14
v_mov_b32 v121, v14
v_mov_b32 v122, v14
v_mov_b32 v123, v14
v_mov_b32 v124, v14
v_mov_b32 v125, v14
v_mov_b32 v126, v14
v_mov_b32 v127, v14
s_cmp_le_u32 s23, 2
s_cbranch_scc1 K2_NOINV
v_mov_b32 v128, v14
v_mov_b32 v129, v14
v_mov_b32 v130, v14
v_mov_b32 v131, v14
v_mov_b32 v132, v14
v_mov_b32 v133, v14
v_mov_b32 v134, v14
v_mov_b32 v135, v14
v_mov_b32 v136, v14
v_mov_b32 v137, v14
v_mov_b32 v138, v14
v_mov_b32 v139, v14
v_mov_b32 v140, v14
v_mov_b32 v141, v14
v_mov_b32 v142, v14
v_mov_b32 v143, v14
s_cmp_le_u32 s23, 3
s_cbranch_scc1 K2_NOINV
v_mov_b32 v144, v14
v_mov_b32 v145, v14
v_mov_b32 v146, v14
v_mov_b32 v147, v14
v_mov_b32 v148, v14
v_mov_b32 v149, v14
v_mov_b32 v150, v14
v_mov_b32 v151, v14
v_mov_b32 v152, v14
v_mov_b32 v153, v14
v_mov_b32 v154, v14
v_mov_b32 v155, v14
v_mov_b32 v156, v14
v_mov_b32 v157, v14
v_mov_b32 v158, v14
v_mov_b32 v159, v14
s_cmp_le_u32 s23, 4
s_cbranch_scc1 K2_NOINV
v_mov_b32 v160, v14
v_mov_b32 v161, v14
v_mov_b32 v162, v14
v_mov_b32 v163, v14
v_mov_b32 v164, v14
v_mov_b32 v165, v14
v_mov_b32 v166, v14
v_mov_b32 v167, v14
v_mov_b32 v168, v14
v_mov_b32 v169, v14
v_mov_b32 v170, v14
v_mov_b32 v171, v14
v_mov_b32 v172, v14
v_mov_b32 v173, v14
v_mov_b32 v174, v14
v_mov_b32 v175, v14
s_cmp_le_u32 s23, 5
s_cbranch_scc1 K2_NOINV
v_mov_b32 v176, v14
v_mov_b32 v177, v14
v_mov_b32 v178, v14
v_mov_b32 v179, v14
v_mov_b32 v180, v14
v_mov_b32 v181, v14
v_mov_b32 v182, v14
v_mov_b32 v183, v14
v_mov_b32 v184, v14
v_mov_b32 v185, v14
v_mov_b32 v186, v14
v_mov_b32 v187, v14
v_mov_b32 v188, v14
v_mov_b32 v189, v14
v_mov_b32 v190, v14
v_mov_b32 v191, v14
s_cmp_le_u32 s23, 6
s_cbranch_scc1 K2_NOINV
v_mov_b32 v192, v14
v_mov_b32 v193, v14
v_mov_b32 v194, v14
v_mov_b32 v195, v14
v_mov_b32 v196, v14
v_mov_b32 v197, v14
v_mov_b32 v198, v14
v_mov_b32 v199, v14
v_mov_b32 v200, v14
v_mov_b32 v201, v14
v_mov_b32 v202, v14
v_mov_b32 v203, v14
v_mov_b32 v204, v14
v_mov_b32 v205, v14
v_mov_b32 v206, v14
v_mov_b32 v207, v14
s_cmp_le_u32 s23, 7
s_cbranch_scc1 K2_NOINV
v_mov_b32 v208, v14
v_mov_b32 v209, v14
v_mov_b32 v210, v14
v_mov_b32 v211, v14
v_mov_b32 v212, v14
v_mov_b32 v213, v14
v_mov_b32 v214, v14
v_mov_b32 v215, v14
v_mov_b32 v216, v14
v_mov_b32 v217, v14
v_mov_b32 v218, v14
v_mov_b32 v219, v14
v_mov_b32 v220, v14
v_mov_b32 v221, v14
v_mov_b32 v222, v14
v_mov_b32 v223, v14
K2_NOINV:
s_waitcnt vmcnt(2) lgkmcnt(0)
s_barrier
ds_read_b128 v[16:19], v3 offset:0
ds_read_b128 v[20:23], v3 offset:1024
ds_read_b128 v[24:27], v3 offset:2048
ds_read_b128 v[28:31], v3 offset:3072
ds_read_b128 v[32:35], v3 offset:4096
ds_read_b128 v[36:39], v3 offset:5120
ds_read_b128 v[40:43], v3 offset:6144
ds_read_b128 v[44:47], v3 offset:7168
ds_read_b128 v[48:51], v3 offset:8192
s_waitcnt lgkmcnt(8)
v_mfma_f32_32x32x16_bf16 v[96:111], v[16:19], v[4:7], v[96:111]
s_waitcnt lgkmcnt(7)
s_cmp_gt_u32 s23, 1
s_cbranch_scc1 K2_I1
v_mfma_f32_32x32x16_bf16 v[112:127], v[20:23], v[4:7], 0
s_branch K2_J1
K2_I1:
v_mfma_f32_32x32x16_bf16 v[112:127], v[20:23], v[4:7], v[112:127]
K2_J1:
s_waitcnt lgkmcnt(6)
s_cmp_gt_u32 s23, 2
s_cbranch_scc1 K2_I2
v_mfma_f32_32x32x16_bf16 v[128:143], v[24:27], v[4:7], 0
s_branch K2_J2
K2_I2:
v_mfma_f32_32x32x16_bf16 v[128:143], v[24:27], v[4:7], v[128:143]
K2_J2:
s_waitcnt lgkmcnt(5)
s_cmp_gt_u32 s23, 3
s_cbranch_scc1 K2_I3
v_mfma_f32_32x32x16_bf16 v[144:159], v[28:31], v[4:7], 0
s_branch K2_J3
K2_I3:
v_mfma_f32_32x32x16_bf16 v[144:159], v[28:31], v[4:7], v[144:159]
K2_J3:
s_waitcnt lgkmcnt(4)
s_cmp_gt_u32 s23, 4
s_cbranch_scc1 K2_I4
v_mfma_f32_32x32x16_bf16 v[160:175], v[32:35], v[4:7], 0
s_branch K2_J4
K2_I4:
v_mfma_f32_32x32x16_bf16 v[160:175], v[32:35], v[4:7], v[160:175]
K2_J4:
s_waitcnt lgkmcnt(3)
s_cmp_gt_u32 s23, 5
s_cbranch_scc1 K2_I5
v_mfma_f32_32x32x16_bf16 v[176:191], v[36:39], v[4:7], 0
s_branch K2_J5
K2_I5:
v_mfma_f32_32x32x16_bf16 v[176:191], v[36:39], v[4:7], v[176:191]
K2_J5:
s_waitcnt lgkmcnt(2)
s_cmp_gt_u32 s23, 6
s_cbranch_scc1 K2_I6
v_mfma_f32_32x32x16_bf16 v[192:207], v[40:43], v[4:7], 0
s_branch K2_J6
K2_I6:
v_mfma_f32_32x32x16_bf16 v[192:207], v[40:43], v[4:7], v[192:207]
K2_J6:
s_waitcnt lgkmcnt(1)
s_cmp_gt_u32 s23, 7
s_cbranch_scc1 K2_I7
v_mfma_f32_32x32x16_bf16 v[208:223], v[44:47], v[4:7], 0
s_branch K2_J7
K2_I7:
v_mfma_f32_32x32x16_bf16 v[208:223], v[44:47], v[4:7], v[208:223]
K2_J7:
s_waitcnt lgkmcnt(0)
v_mfma_f32_32x32x16_bf16 v[224:239], v[48:51], v[4:7], v[224:239]
s_waitcnt vmcnt(0)
s_barrier
s_lshl_b32 s28, s45, 16
s_lshl_b32 s29, s10, 13
s_add_u32 s28, s28, s29
s_add_u32 s28, s28, 14680064
s_add_u32 s30, s4, s28
s_addc_u32 s31, s5, 0
s_add_u32 s29, s29, 65536
s_add_u32 m0, s29, 0
s_nop 0
global_load_lds_dwordx4 v2, s[30:31] offset:0
global_load_lds_dwordx4 v2, s[30:31] offset:1024
global_load_lds_dwordx4 v2, s[30:31] offset:2048
global_load_lds_dwordx4 v2, s[30:31] offset:3072
s_add_u32 s30, s30, 4096
s_addc_u32 s31, s31, 0
s_add_u32 m0, s29, 4096
s_nop 0
global_load_lds_dwordx4 v2, s[30:31] offset:0
global_load_lds_dwordx4 v2, s[30:31] offset:1024
global_load_lds_dwordx4 v2, s[30:31] offset:2048
global_load_lds_dwordx4 v2, s[30:31] offset:3072
ds_read_b128 v[16:19], v8 offset:0
ds_read_b128 v[20:23], v8 offset:512
ds_read_b128 v[24:27], v8 offset:1024
ds_read_b128 v[28:31], v8 offset:1536
ds_read_b128 v[32:35], v8 offset:2048
ds_read_b128 v[36:39], v8 offset:2560
ds_read_b128 v[40:43], v8 offset:3072
ds_read_b128 v[44:47], v8 offset:3584
ds_read_b128 v[48:51], v8 offset:4096
ds_read_b128 v[52:55], v8 offset:4608
ds_read_b128 v[56:59], v8 offset:5120
ds_read_b128 v[60:63], v8 offset:5632
ds_read_b128 v[64:67], v8 offset:6144
ds_read_b128 v[68:71], v8 offset:6656
ds_read_b128 v[72:75], v8 offset:7168
ds_read_b128 v[76:79], v8 offset:7680
ds_read_b128 v[80:83], v8 offset:8192
ds_read_b128 v[84:87], v8 offset:8704
v_max3_f32 v88, v96, v97, v98
v_max3_f32 v89, v99, v100, v101
v_max3_f32 v90, v102, v103, v104
v_max3_f32 v91, v105, v106, v107
v_max3_f32 v88, v88, v108, v109
v_max3_f32 v89, v89, v110, v111
v_max3_f32 v90, v90, v112, v113
v_max3_f32 v91, v91, v114, v115
v_max3_f32 v88, v88, v116, v117
v_max3_f32 v89, v89, v118, v119
v_max3_f32 v90, v90, v120, v121
v_max3_f32 v91, v91, v122, v123
v_max3_f32 v88, v88, v124, v125
v_max3_f32 v89, v89, v126, v127
v_max3_f32 v90, v90, v128, v129
v_max3_f32 v91, v91, v130, v131
v_max3_f32 v88, v88, v132, v133
v_max3_f32 v89, v89, v134, v135
v_max3_f32 v90, v90, v136, v137
v_max3_f32 v91, v91, v138, v139
v_max3_f32 v88, v88, v140, v141
v_max3_f32 v89, v89, v142, v143
v_max3_f32 v90, v90, v144, v145
v_max3_f32 v91, v91, v146, v147
v_max3_f32 v88, v88, v148, v149
v_max3_f32 v89, v89, v150, v151
v_max3_f32 v90, v90, v152, v153
v_max3_f32 v91, v91, v154, v155
v_max3_f32 v88, v88, v156, v157
v_max3_f32 v89, v89, v158, v159
v_max3_f32 v90, v90, v160, v161
v_max3_f32 v91, v91, v162, v163
v_max3_f32 v88, v88, v164, v165
v_max3_f32 v89, v89, v166, v167
v_max3_f32 v90, v90, v168, v169
v_max3_f32 v91, v91, v170, v171
v_max3_f32 v88, v88, v172, v173
v_max3_f32 v89, v89, v174, v175
v_max3_f32 v90, v90, v176, v177
v_max3_f32 v91, v91, v178, v179
v_max3_f32 v88, v88, v180, v181
v_max3_f32 v89, v89, v182, v183
v_max3_f32 v90, v90, v184, v185
v_max3_f32 v91, v91, v186, v187
v_max3_f32 v88, v88, v188, v189
v_max3_f32 v89, v89, v190, v191
v_max3_f32 v90, v90, v192, v193
v_max3_f32 v91, v91, v194, v195
v_max3_f32 v88, v88, v196, v197
v_max3_f32 v89, v89, v198, v199
v_max3_f32 v90, v90, v200, v201
v_max3_f32 v91, v91, v202, v203
v_max3_f32 v88, v88, v204, v205
v_max3_f32 v89, v89, v206, v207
v_max3_f32 v90, v90, v208, v209
v_max3_f32 v91, v91, v210, v211
v_max3_f32 v88, v88, v212, v213
v_max3_f32 v89, v89, v214, v215
v_max3_f32 v90, v90, v216, v217
v_max3_f32 v91, v91, v218, v219
v_max3_f32 v88, v88, v220, v221
v_max3_f32 v89, v89, v222, v223
v_max3_f32 v90, v90, v224, v225
v_max3_f32 v91, v91, v226, v227
v_max3_f32 v88, v88, v228, v229
v_max3_f32 v89, v89, v230, v231
v_max3_f32 v90, v90, v232, v233
v_max3_f32 v91, v91, v234, v235
v_max3_f32 v88, v88, v236, v237
v_max3_f32 v89, v89, v238, v239
v_max3_f32 v88, v88, v89, v90
v_max_f32 v88, v88, v91
v_mov_b32 v89, v88
s_nop 1
v_permlane32_swap_b32 v88, v89
v_max_f32 v88, v88, v89
v_sub_f32 v88, 0, v88
v_pk_add_f32 v[96:97], v[96:97], v[88:89] op_sel_hi:[1,0]
v_pk_add_f32 v[98:99], v[98:99], v[88:89] op_sel_hi:[1,0]
v_pk_add_f32 v[100:101], v[100:101], v[88:89] op_sel_hi:[1,0]
v_pk_add_f32 v[102:103], v[102:103], v[88:89] op_sel_hi:[1,0]
v_pk_add_f32 v[104:105], v[104:105], v[88:89] op_sel_hi:[1,0]
v_pk_add_f32 v[106:107], v[106:107], v[88:89] op_sel_hi:[1,0]
v_pk_add_f32 v[108:109], v[108:109], v[88:89] op_sel_hi:[1,0]
v_pk_add_f32 v[110:111], v[110:111], v[88:89] op_sel_hi:[1,0]
v_exp_f32 v96, v96
v_exp_f32 v97, v97
v_exp_f32 v98, v98
v_exp_f32 v99, v99
v_exp_f32 v100, v100
v_exp_f32 v101, v101
v_exp_f32 v102, v102
v_exp_f32 v103, v103
v_exp_f32 v104, v104
v_exp_f32 v105, v105
v_exp_f32 v106, v106
v_exp_f32 v107, v107
v_exp_f32 v108, v108
v_exp_f32 v109, v109
v_exp_f32 v110, v110
v_exp_f32 v111, v111
v_cvt_pk_bf16_f32 v96, v96, v97
v_cvt_pk_bf16_f32 v97, v98, v99
v_cvt_pk_bf16_f32 v98, v100, v101
v_cvt_pk_bf16_f32 v99, v102, v103
v_cvt_pk_bf16_f32 v100, v104, v105
v_cvt_pk_bf16_f32 v101, v106, v107
v_cvt_pk_bf16_f32 v102, v108, v109
v_cvt_pk_bf16_f32 v103, v110, v111
s_waitcnt lgkmcnt(0)
v_mfma_f32_32x32x16_bf16 v[240:255], v[16:19], v[96:99], 0
v_mfma_f32_32x32x16_bf16 v[240:255], v[20:23], v[100:103], v[240:255]
v_pk_add_f32 v[112:113], v[112:113], v[88:89] op_sel_hi:[1,0]
v_pk_add_f32 v[114:115], v[114:115], v[88:89] op_sel_hi:[1,0]
v_pk_add_f32 v[116:117], v[116:117], v[88:89] op_sel_hi:[1,0]
v_pk_add_f32 v[118:119], v[118:119], v[88:89] op_sel_hi:[1,0]
v_pk_add_f32 v[120:121], v[120:121], v[88:89] op_sel_hi:[1,0]
v_pk_add_f32 v[122:123], v[122:123], v[88:89] op_sel_hi:[1,0]
v_pk_add_f32 v[124:125], v[124:125], v[88:89] op_sel_hi:[1,0]
v_pk_add_f32 v[126:127], v[126:127], v[88:89] op_sel_hi:[1,0]
v_exp_f32 v112, v112
v_exp_f32 v113, v113
v_exp_f32 v114, v114
v_exp_f32 v115, v115
v_exp_f32 v116, v116
v_exp_f32 v117, v117
v_exp_f32 v118, v118
v_exp_f32 v119, v119
v_exp_f32 v120, v120
v_exp_f32 v121, v121
v_exp_f32 v122, v122
v_exp_f32 v123, v123
v_exp_f32 v124, v124
v_exp_f32 v125, v125
v_exp_f32 v126, v126
v_exp_f32 v127, v127
v_cvt_pk_bf16_f32 v112, v112, v113
v_cvt_pk_bf16_f32 v113, v114, v115
v_cvt_pk_bf16_f32 v114, v116, v117
v_cvt_pk_bf16_f32 v115, v118, v119
v_cvt_pk_bf16_f32 v116, v120, v121
v_cvt_pk_bf16_f32 v117, v122, v123
v_cvt_pk_bf16_f32 v118, v124, v125
v_cvt_pk_bf16_f32 v119, v126, v127
v_mfma_f32_32x32x16_bf16 v[240:255], v[24:27], v[112:115], v[240:255]
s_nop 0
v_mfma_f32_32x32x16_bf16 v[240:255], v[28:31], v[116:119], v[240:255]
v_pk_add_f32 v[128:129], v[128:129], v[88:89] op_sel_hi:[1,0]
v_pk_add_f32 v[130:131], v[130:131], v[88:89] op_sel_hi:[1,0]
v_pk_add_f32 v[132:133], v[132:133], v[88:89] op_sel_hi:[1,0]
v_pk_add_f32 v[134:135], v[134:135], v[88:89] op_sel_hi:[1,0]
v_pk_add_f32 v[136:137], v[136:137], v[88:89] op_sel_hi:[1,0]
v_pk_add_f32 v[138:139], v[138:139], v[88:89] op_sel_hi:[1,0]
v_pk_add_f32 v[140:141], v[140:141], v[88:89] op_sel_hi:[1,0]
v_pk_add_f32 v[142:143], v[142:143], v[88:89] op_sel_hi:[1,0]
v_exp_f32 v128, v128
v_exp_f32 v129, v129
v_exp_f32 v130, v130
v_exp_f32 v131, v131
v_exp_f32 v132, v132
v_exp_f32 v133, v133
v_exp_f32 v134, v134
v_exp_f32 v135, v135
v_exp_f32 v136, v136
v_exp_f32 v137, v137
v_exp_f32 v138, v138
v_exp_f32 v139, v139
v_exp_f32 v140, v140
v_exp_f32 v141, v141
v_exp_f32 v142, v142
v_exp_f32 v143, v143
v_cvt_pk_bf16_f32 v128, v128, v129
v_cvt_pk_bf16_f32 v129, v130, v131
v_cvt_pk_bf16_f32 v130, v132, v133
v_cvt_pk_bf16_f32 v131, v134, v135
v_cvt_pk_bf16_f32 v132, v136, v137
v_cvt_pk_bf16_f32 v133, v138, v139
v_cvt_pk_bf16_f32 v134, v140, v141
v_cvt_pk_bf16_f32 v135, v142, v143
v_mfma_f32_32x32x16_bf16 v[240:255], v[32:35], v[128:131], v[240:255]
s_nop 0
v_mfma_f32_32x32x16_bf16 v[240:255], v[36:39], v[132:135], v[240:255]
v_pk_add_f32 v[144:145], v[144:145], v[88:89] op_sel_hi:[1,0]
v_pk_add_f32 v[146:147], v[146:147], v[88:89] op_sel_hi:[1,0]
v_pk_add_f32 v[148:149], v[148:149], v[88:89] op_sel_hi:[1,0]
v_pk_add_f32 v[150:151], v[150:151], v[88:89] op_sel_hi:[1,0]
v_pk_add_f32 v[152:153], v[152:153], v[88:89] op_sel_hi:[1,0]
v_pk_add_f32 v[154:155], v[154:155], v[88:89] op_sel_hi:[1,0]
v_pk_add_f32 v[156:157], v[156:157], v[88:89] op_sel_hi:[1,0]
v_pk_add_f32 v[158:159], v[158:159], v[88:89] op_sel_hi:[1,0]
v_exp_f32 v144, v144
v_exp_f32 v145, v145
v_exp_f32 v146, v146
v_exp_f32 v147, v147
v_exp_f32 v148, v148
v_exp_f32 v149, v149
v_exp_f32 v150, v150
v_exp_f32 v151, v151
v_exp_f32 v152, v152
v_exp_f32 v153, v153
v_exp_f32 v154, v154
v_exp_f32 v155, v155
v_exp_f32 v156, v156
v_exp_f32 v157, v157
v_exp_f32 v158, v158
v_exp_f32 v159, v159
v_cvt_pk_bf16_f32 v144, v144, v145
v_cvt_pk_bf16_f32 v145, v146, v147
v_cvt_pk_bf16_f32 v146, v148, v149
v_cvt_pk_bf16_f32 v147, v150, v151
v_cvt_pk_bf16_f32 v148, v152, v153
v_cvt_pk_bf16_f32 v149, v154, v155
v_cvt_pk_bf16_f32 v150, v156, v157
v_cvt_pk_bf16_f32 v151, v158, v159
v_mfma_f32_32x32x16_bf16 v[240:255], v[40:43], v[144:147], v[240:255]
s_nop 0
v_mfma_f32_32x32x16_bf16 v[240:255], v[44:47], v[148:151], v[240:255]
v_pk_add_f32 v[160:161], v[160:161], v[88:89] op_sel_hi:[1,0]
v_pk_add_f32 v[162:163], v[162:163], v[88:89] op_sel_hi:[1,0]
v_pk_add_f32 v[164:165], v[164:165], v[88:89] op_sel_hi:[1,0]
v_pk_add_f32 v[166:167], v[166:167], v[88:89] op_sel_hi:[1,0]
v_pk_add_f32 v[168:169], v[168:169], v[88:89] op_sel_hi:[1,0]
v_pk_add_f32 v[170:171], v[170:171], v[88:89] op_sel_hi:[1,0]
v_pk_add_f32 v[172:173], v[172:173], v[88:89] op_sel_hi:[1,0]
v_pk_add_f32 v[174:175], v[174:175], v[88:89] op_sel_hi:[1,0]
v_exp_f32 v160, v160
v_exp_f32 v161, v161
v_exp_f32 v162, v162
v_exp_f32 v163, v163
v_exp_f32 v164, v164
v_exp_f32 v165, v165
v_exp_f32 v166, v166
v_exp_f32 v167, v167
v_exp_f32 v168, v168
v_exp_f32 v169, v169
v_exp_f32 v170, v170
v_exp_f32 v171, v171
v_exp_f32 v172, v172
v_exp_f32 v173, v173
v_exp_f32 v174, v174
v_exp_f32 v175, v175
v_cvt_pk_bf16_f32 v160, v160, v161
v_cvt_pk_bf16_f32 v161, v162, v163
v_cvt_pk_bf16_f32 v162, v164, v165
v_cvt_pk_bf16_f32 v163, v166, v167
v_cvt_pk_bf16_f32 v164, v168, v169
v_cvt_pk_bf16_f32 v165, v170, v171
v_cvt_pk_bf16_f32 v166, v172, v173
v_cvt_pk_bf16_f32 v167, v174, v175
v_mfma_f32_32x32x16_bf16 v[240:255], v[48:51], v[160:163], v[240:255]
s_nop 0
v_mfma_f32_32x32x16_bf16 v[240:255], v[52:55], v[164:167], v[240:255]
v_pk_add_f32 v[176:177], v[176:177], v[88:89] op_sel_hi:[1,0]
v_pk_add_f32 v[178:179], v[178:179], v[88:89] op_sel_hi:[1,0]
v_pk_add_f32 v[180:181], v[180:181], v[88:89] op_sel_hi:[1,0]
v_pk_add_f32 v[182:183], v[182:183], v[88:89] op_sel_hi:[1,0]
v_pk_add_f32 v[184:185], v[184:185], v[88:89] op_sel_hi:[1,0]
v_pk_add_f32 v[186:187], v[186:187], v[88:89] op_sel_hi:[1,0]
v_pk_add_f32 v[188:189], v[188:189], v[88:89] op_sel_hi:[1,0]
v_pk_add_f32 v[190:191], v[190:191], v[88:89] op_sel_hi:[1,0]
v_exp_f32 v176, v176
v_exp_f32 v177, v177
v_exp_f32 v178, v178
v_exp_f32 v179, v179
v_exp_f32 v180, v180
v_exp_f32 v181, v181
v_exp_f32 v182, v182
v_exp_f32 v183, v183
v_exp_f32 v184, v184
v_exp_f32 v185, v185
v_exp_f32 v186, v186
v_exp_f32 v187, v187
v_exp_f32 v188, v188
v_exp_f32 v189, v189
v_exp_f32 v190, v190
v_exp_f32 v191, v191
v_cvt_pk_bf16_f32 v176, v176, v177
v_cvt_pk_bf16_f32 v177, v178, v179
v_cvt_pk_bf16_f32 v178, v180, v181
v_cvt_pk_bf16_f32 v179, v182, v183
v_cvt_pk_bf16_f32 v180, v184, v185
v_cvt_pk_bf16_f32 v181, v186, v187
v_cvt_pk_bf16_f32 v182, v188, v189
v_cvt_pk_bf16_f32 v183, v190, v191
v_mfma_f32_32x32x16_bf16 v[240:255], v[56:59], v[176:179], v[240:255]
s_nop 0
v_mfma_f32_32x32x16_bf16 v[240:255], v[60:63], v[180:183], v[240:255]
v_pk_add_f32 v[192:193], v[192:193], v[88:89] op_sel_hi:[1,0]
v_pk_add_f32 v[194:195], v[194:195], v[88:89] op_sel_hi:[1,0]
v_pk_add_f32 v[196:197], v[196:197], v[88:89] op_sel_hi:[1,0]
v_pk_add_f32 v[198:199], v[198:199], v[88:89] op_sel_hi:[1,0]
v_pk_add_f32 v[200:201], v[200:201], v[88:89] op_sel_hi:[1,0]
v_pk_add_f32 v[202:203], v[202:203], v[88:89] op_sel_hi:[1,0]
v_pk_add_f32 v[204:205], v[204:205], v[88:89] op_sel_hi:[1,0]
v_pk_add_f32 v[206:207], v[206:207], v[88:89] op_sel_hi:[1,0]
v_exp_f32 v192, v192
v_exp_f32 v193, v193
v_exp_f32 v194, v194
v_exp_f32 v195, v195
v_exp_f32 v196, v196
v_exp_f32 v197, v197
v_exp_f32 v198, v198
v_exp_f32 v199, v199
v_exp_f32 v200, v200
v_exp_f32 v201, v201
v_exp_f32 v202, v202
v_exp_f32 v203, v203
v_exp_f32 v204, v204
v_exp_f32 v205, v205
v_exp_f32 v206, v206
v_exp_f32 v207, v207
v_cvt_pk_bf16_f32 v192, v192, v193
v_cvt_pk_bf16_f32 v193, v194, v195
v_cvt_pk_bf16_f32 v194, v196, v197
v_cvt_pk_bf16_f32 v195, v198, v199
v_cvt_pk_bf16_f32 v196, v200, v201
v_cvt_pk_bf16_f32 v197, v202, v203
v_cvt_pk_bf16_f32 v198, v204, v205
v_cvt_pk_bf16_f32 v199, v206, v207
v_mfma_f32_32x32x16_bf16 v[240:255], v[64:67], v[192:195], v[240:255]
s_nop 0
v_mfma_f32_32x32x16_bf16 v[240:255], v[68:71], v[196:199], v[240:255]
v_pk_add_f32 v[208:209], v[208:209], v[88:89] op_sel_hi:[1,0]
v_pk_add_f32 v[210:211], v[210:211], v[88:89] op_sel_hi:[1,0]
v_pk_add_f32 v[212:213], v[212:213], v[88:89] op_sel_hi:[1,0]
v_pk_add_f32 v[214:215], v[214:215], v[88:89] op_sel_hi:[1,0]
v_pk_add_f32 v[216:217], v[216:217], v[88:89] op_sel_hi:[1,0]
v_pk_add_f32 v[218:219], v[218:219], v[88:89] op_sel_hi:[1,0]
v_pk_add_f32 v[220:221], v[220:221], v[88:89] op_sel_hi:[1,0]
v_pk_add_f32 v[222:223], v[222:223], v[88:89] op_sel_hi:[1,0]
v_exp_f32 v208, v208
v_exp_f32 v209, v209
v_exp_f32 v210, v210
v_exp_f32 v211, v211
v_exp_f32 v212, v212
v_exp_f32 v213, v213
v_exp_f32 v214, v214
v_exp_f32 v215, v215
v_exp_f32 v216, v216
v_exp_f32 v217, v217
v_exp_f32 v218, v218
v_exp_f32 v219, v219
v_exp_f32 v220, v220
v_exp_f32 v221, v221
v_exp_f32 v222, v222
v_exp_f32 v223, v223
v_cvt_pk_bf16_f32 v208, v208, v209
v_cvt_pk_bf16_f32 v209, v210, v211
v_cvt_pk_bf16_f32 v210, v212, v213
v_cvt_pk_bf16_f32 v211, v214, v215
v_cvt_pk_bf16_f32 v212, v216, v217
v_cvt_pk_bf16_f32 v213, v218, v219
v_cvt_pk_bf16_f32 v214, v220, v221
v_cvt_pk_bf16_f32 v215, v222, v223
v_mfma_f32_32x32x16_bf16 v[240:255], v[72:75], v[208:211], v[240:255]
s_nop 0
v_mfma_f32_32x32x16_bf16 v[240:255], v[76:79], v[212:215], v[240:255]
v_pk_add_f32 v[224:225], v[224:225], v[88:89] op_sel_hi:[1,0]
v_pk_add_f32 v[226:227], v[226:227], v[88:89] op_sel_hi:[1,0]
v_pk_add_f32 v[228:229], v[228:229], v[88:89] op_sel_hi:[1,0]
v_pk_add_f32 v[230:231], v[230:231], v[88:89] op_sel_hi:[1,0]
v_pk_add_f32 v[232:233], v[232:233], v[88:89] op_sel_hi:[1,0]
v_pk_add_f32 v[234:235], v[234:235], v[88:89] op_sel_hi:[1,0]
v_pk_add_f32 v[236:237], v[236:237], v[88:89] op_sel_hi:[1,0]
v_pk_add_f32 v[238:239], v[238:239], v[88:89] op_sel_hi:[1,0]
v_exp_f32 v224, v224
v_exp_f32 v225, v225
v_exp_f32 v226, v226
v_exp_f32 v227, v227
v_exp_f32 v228, v228
v_exp_f32 v229, v229
v_exp_f32 v230, v230
v_exp_f32 v231, v231
v_exp_f32 v232, v232
v_exp_f32 v233, v233
v_exp_f32 v234, v234
v_exp_f32 v235, v235
v_exp_f32 v236, v236
v_exp_f32 v237, v237
v_exp_f32 v238, v238
v_exp_f32 v239, v239
v_cvt_pk_bf16_f32 v224, v224, v225
v_cvt_pk_bf16_f32 v225, v226, v227
v_cvt_pk_bf16_f32 v226, v228, v229
v_cvt_pk_bf16_f32 v227, v230, v231
v_cvt_pk_bf16_f32 v228, v232, v233
v_cvt_pk_bf16_f32 v229, v234, v235
v_cvt_pk_bf16_f32 v230, v236, v237
v_cvt_pk_bf16_f32 v231, v238, v239
v_mfma_f32_32x32x16_bf16 v[240:255], v[80:83], v[224:227], v[240:255]
s_nop 0
v_mfma_f32_32x32x16_bf16 v[240:255], v[84:87], v[228:231], v[240:255]
s_nop 11
v_rcp_f32 v88, v248
s_nop 10
v_pk_mul_f32 v[240:241], v[240:241], v[88:89] op_sel_hi:[1,0]
s_nop 9
v_pk_mul_f32 v[242:243], v[242:243], v[88:89] op_sel_hi:[1,0]
s_nop 8
v_pk_mul_f32 v[244:245], v[244:245], v[88:89] op_sel_hi:[1,0]
s_nop 7
v_pk_mul_f32 v[246:247], v[246:247], v[88:89] op_sel_hi:[1,0]
s_nop 6
v_cvt_pk_bf16_f32 v4, v240, v241
s_nop 5
v_cvt_pk_bf16_f32 v5, v242, v243
s_nop 4
v_cvt_pk_bf16_f32 v6, v244, v245
s_nop 3
v_cvt_pk_bf16_f32 v7, v246, v247
s_lshl_b32 s12, s8, 3
s_add_u32 s12, s12, s10
s_lshl_b32 s12, s12, 5
s_add_u32 s12, s12, s9
s_lshl_b32 s12, s12, 10
s_add_u32 s12, s12, 10485760
s_add_u32 s40, s4, s12
s_addc_u32 s41, s5, 0
global_store_dwordx4 v2, v[4:7], s[40:41] sc1
s_waitcnt vmcnt(0)
s_barrier
s_lshl_b32 s42, s8, 12
s_add_u32 s42, s42, 15310848
s_add_u32 s42, s4, s42
s_addc_u32 s43, s5, 0
s_cmp_lt_u32 s10, 4
s_cbranch_scc1 K3_NA
s_cmp_gt_u32 s10, 4
s_cbranch_scc1 K2_END
s_and_b32 s44, s2, 31
s_lshl_b32 s44, s44, 2
v_lshlrev_b32 v12, 7, v1
v_add_u32 v12, s44, v12
v_mov_b32 v13, 1
s_mov_b32 exec_hi, 0
global_store_dword v12, v13, s[42:43] sc1
s_mov_b64 exec, -1
s_waitcnt vmcnt(0)
v_and_b32 v12, 31, v1
v_lshlrev_b32 v12, 2, v12
s_and_b32 s44, s2, 31
s_lshl_b32 s44, s44, 7
v_add_u32 v12, s44, v12
K3_POLL:
global_load_dword v13, v12, s[42:43] sc1
s_waitcnt vmcnt(0)
v_cmp_eq_u32 vcc, 0, v13
s_cbranch_vccnz K3_POLL
s_barrier
s_branch K2_END
K3_NA:
s_and_b32 s11, s2, 3
s_lshl_b32 s8, s8, 2
s_add_u32 s8, s8, s11
s_mov_b32 s9, s45
s_lshr_b32 s11, s10, 1
s_and_b32 s12, s10, 1
v_and_b32 v3, 31, v1
v_lshrrev_b32 v4, 5, v1
s_lshl_b32 s18, s8, 6
s_lshl_b32 s19, s11, 5
s_add_u32 s18, s18, s19
v_add_u32 v5, s18, v3
s_lshl_b32 s18, s9, 6
s_lshl_b32 s19, s12, 5
s_add_u32 s18, s18, s19
v_lshlrev_b32 v6, 4, v4
v_add_u32 v6, s18, v6
v_lshlrev_b32 v7, 10, v5
v_lshlrev_b32 v8, 1, v6
v_add_u32 v7, v7, v8
v_lshlrev_b32 v8, 2, v6
s_add_u32 s20, s4, 15204352
s_addc_u32 s21, s5, 0
s_add_u32 s22, s4, 15212544
s_addc_u32 s23, s5, 0
global_load_dwordx4 v[16:19], v7, s[26:27]
global_load_dwordx4 v[20:23], v7, s[26:27] offset:16
global_load_dwordx4 v[24:27], v8, s[20:21] offset:0
global_load_dwordx4 v[28:31], v8, s[20:21] offset:16
global_load_dwordx4 v[32:35], v8, s[20:21] offset:32
global_load_dwordx4 v[36:39], v8, s[20:21] offset:48
global_load_dwordx4 v[40:43], v8, s[22:23] offset:0
global_load_dwordx4 v[44:47], v8, s[22:23] offset:16
global_load_dwordx4 v[48:51], v8, s[22:23] offset:32
global_load_dwordx4 v[52:55], v8, s[22:23] offset:48
s_lshl_b32 s13, s8, 1
s_add_u32 s13, s13, s12
s_lshl_b32 s13, s13, 15
s_lshl_b32 s14, s11, 12
s_add_u32 s13, s13, s14
s_add_u32 s13, s13, 10485760
s_add_u32 s16, s4, s13
s_addc_u32 s17, s5, 0
s_lshl_b32 s15, s12, 15
s_add_u32 s15, s15, s14
s_barrier
s_add_u32 m0, s15, 0
s_nop 0
global_load_lds_dwordx4 v2, s[16:17] offset:0
global_load_lds_dwordx4 v2, s[16:17] offset:1024
global_load_lds_dwordx4 v2, s[16:17] offset:2048
global_load_lds_dwordx4 v2, s[16:17] offset:3072
s_add_u32 s16, s16, 8192
s_addc_u32 s17, s17, 0
s_add_u32 m0, s15, 8192
s_nop 0
global_load_lds_dwordx4 v2, s[16:17] offset:0
global_load_lds_dwordx4 v2, s[16:17] offset:1024
global_load_lds_dwordx4 v2, s[16:17] offset:2048
global_load_lds_dwordx4 v2, s[16:17] offset:3072
s_add_u32 s16, s16, 8192
s_addc_u32 s17, s17, 0
s_add_u32 m0, s15, 16384
s_nop 0
global_load_lds_dwordx4 v2, s[16:17] offset:0
global_load_lds_dwordx4 v2, s[16:17] offset:1024
global_load_lds_dwordx4 v2, s[16:17] offset:2048
global_load_lds_dwordx4 v2, s[16:17] offset:3072
s_add_u32 s16, s16, 8192
s_addc_u32 s17, s17, 0
s_add_u32 m0, s15, 24576
s_nop 0
global_load_lds_dwordx4 v2, s[16:17] offset:0
global_load_lds_dwordx4 v2, s[16:17] offset:1024
global_load_lds_dwordx4 v2, s[16:17] offset:2048
global_load_lds_dwordx4 v2, s[16:17] offset:3072
s_lshl_b32 s18, s11, 15
v_add_u32 v9, s18, v2
s_lshl_b32 s18, s12, 15
s_add_u32 s18, s18, 65536
v_add_u32 v10, s18, v2
s_waitcnt vmcnt(12)
s_barrier
ds_read_b128 v[64:67], v10 offset:0
ds_read_b128 v[68:71], v9 offset:0
ds_read_b128 v[72:75], v10 offset:1024
ds_read_b128 v[76:79], v9 offset:1024
ds_read_b128 v[80:83], v10 offset:2048
ds_read_b128 v[84:87], v9 offset:2048
ds_read_b128 v[88:91], v10 offset:3072
ds_read_b128 v[92:95], v9 offset:3072
s_waitcnt lgkmcnt(6)
v_mfma_f32_32x32x16_bf16 v[96:111], v[64:67], v[68:71], 0
ds_read_b128 v[64:67], v10 offset:4096
ds_read_b128 v[68:71], v9 offset:4096
s_waitcnt lgkmcnt(6)
v_mfma_f32_32x32x16_bf16 v[96:111], v[72:75], v[76:79], v[96:111]
ds_read_b128 v[72:75], v10 offset:5120
ds_read_b128 v[76:79], v9 offset:5120
s_waitcnt lgkmcnt(6)
v_mfma_f32_32x32x16_bf16 v[96:111], v[80:83], v[84:87], v[96:111]
ds_read_b128 v[80:83], v10 offset:6144
ds_read_b128 v[84:87], v9 offset:6144
s_waitcnt lgkmcnt(6)
v_mfma_f32_32x32x16_bf16 v[96:111], v[88:91], v[92:95], v[96:111]
ds_read_b128 v[88:91], v10 offset:7168
ds_read_b128 v[92:95], v9 offset:7168
s_waitcnt lgkmcnt(6)
v_mfma_f32_32x32x16_bf16 v[96:111], v[64:67], v[68:71], v[96:111]
s_waitcnt lgkmcnt(4)
v_mfma_f32_32x32x16_bf16 v[96:111], v[72:75], v[76:79], v[96:111]
s_waitcnt lgkmcnt(2)
v_mfma_f32_32x32x16_bf16 v[96:111], v[80:83], v[84:87], v[96:111]
s_waitcnt lgkmcnt(0)
v_mfma_f32_32x32x16_bf16 v[96:111], v[88:91], v[92:95], v[96:111]
s_waitcnt vmcnt(8)
s_barrier
ds_read_b128 v[64:67], v10 offset:8192
ds_read_b128 v[68:71], v9 offset:8192
ds_read_b128 v[72:75], v10 offset:9216
ds_read_b128 v[76:79], v9 offset:9216
ds_read_b128 v[80:83], v10 offset:10240
ds_read_b128 v[84:87], v9 offset:10240
ds_read_b128 v[88:91], v10 offset:11264
ds_read_b128 v[92:95], v9 offset:11264
s_waitcnt lgkmcnt(6)
v_mfma_f32_32x32x16_bf16 v[96:111], v[64:67], v[68:71], v[96:111]
ds_read_b128 v[64:67], v10 offset:12288
ds_read_b128 v[68:71], v9 offset:12288
s_waitcnt lgkmcnt(6)
v_mfma_f32_32x32x16_bf16 v[96:111], v[72:75], v[76:79], v[96:111]
ds_read_b128 v[72:75], v10 offset:13312
ds_read_b128 v[76:79], v9 offset:13312
s_waitcnt lgkmcnt(6)
v_mfma_f32_32x32x16_bf16 v[96:111], v[80:83], v[84:87], v[96:111]
ds_read_b128 v[80:83], v10 offset:14336
ds_read_b128 v[84:87], v9 offset:14336
s_waitcnt lgkmcnt(6)
v_mfma_f32_32x32x16_bf16 v[96:111], v[88:91], v[92:95], v[96:111]
ds_read_b128 v[88:91], v10 offset:15360
ds_read_b128 v[92:95], v9 offset:15360
s_waitcnt lgkmcnt(6)
v_mfma_f32_32x32x16_bf16 v[96:111], v[64:67], v[68:71], v[96:111]
s_waitcnt lgkmcnt(4)
v_mfma_f32_32x32x16_bf16 v[96:111], v[72:75], v[76:79], v[96:111]
s_waitcnt lgkmcnt(2)
v_mfma_f32_32x32x16_bf16 v[96:111], v[80:83], v[84:87], v[96:111]
s_waitcnt lgkmcnt(0)
v_mfma_f32_32x32x16_bf16 v[96:111], v[88:91], v[92:95], v[96:111]
s_waitcnt vmcnt(4)
s_barrier
ds_read_b128 v[64:67], v10 offset:16384
ds_read_b128 v[68:71], v9 offset:16384
ds_read_b128 v[72:75], v10 offset:17408
ds_read_b128 v[76:79], v9 offset:17408
ds_read_b128 v[80:83], v10 offset:18432
ds_read_b128 v[84:87], v9 offset:18432
ds_read_b128 v[88:91], v10 offset:19456
ds_read_b128 v[92:95], v9 offset:19456
s_waitcnt lgkmcnt(6)
v_mfma_f32_32x32x16_bf16 v[96:111], v[64:67], v[68:71], v[96:111]
ds_read_b128 v[64:67], v10 offset:20480
ds_read_b128 v[68:71], v9 offset:20480
s_waitcnt lgkmcnt(6)
v_mfma_f32_32x32x16_bf16 v[96:111], v[72:75], v[76:79], v[96:111]
ds_read_b128 v[72:75], v10 offset:21504
ds_read_b128 v[76:79], v9 offset:21504
s_waitcnt lgkmcnt(6)
v_mfma_f32_32x32x16_bf16 v[96:111], v[80:83], v[84:87], v[96:111]
ds_read_b128 v[80:83], v10 offset:22528
ds_read_b128 v[84:87], v9 offset:22528
s_waitcnt lgkmcnt(6)
v_mfma_f32_32x32x16_bf16 v[96:111], v[88:91], v[92:95], v[96:111]
ds_read_b128 v[88:91], v10 offset:23552
ds_read_b128 v[92:95], v9 offset:23552
s_waitcnt lgkmcnt(6)
v_mfma_f32_32x32x16_bf16 v[96:111], v[64:67], v[68:71], v[96:111]
s_waitcnt lgkmcnt(4)
v_mfma_f32_32x32x16_bf16 v[96:111], v[72:75], v[76:79], v[96:111]
s_waitcnt lgkmcnt(2)
v_mfma_f32_32x32x16_bf16 v[96:111], v[80:83], v[84:87], v[96:111]
s_waitcnt lgkmcnt(0)
v_mfma_f32_32x32x16_bf16 v[96:111], v[88:91], v[92:95], v[96:111]
s_waitcnt vmcnt(0)
s_barrier
ds_read_b128 v[64:67], v10 offset:24576
ds_read_b128 v[68:71], v9 offset:24576
ds_read_b128 v[72:75], v10 offset:25600
ds_read_b128 v[76:79], v9 offset:25600
ds_read_b128 v[80:83], v10 offset:26624
ds_read_b128 v[84:87], v9 offset:26624
ds_read_b128 v[88:91], v10 offset:27648
ds_read_b128 v[92:95], v9 offset:27648
s_waitcnt lgkmcnt(6)
v_mfma_f32_32x32x16_bf16 v[96:111], v[64:67], v[68:71], v[96:111]
ds_read_b128 v[64:67], v10 offset:28672
ds_read_b128 v[68:71], v9 offset:28672
s_waitcnt lgkmcnt(6)
v_mfma_f32_32x32x16_bf16 v[96:111], v[72:75], v[76:79], v[96:111]
ds_read_b128 v[72:75], v10 offset:29696
ds_read_b128 v[76:79], v9 offset:29696
s_waitcnt lgkmcnt(6)
v_mfma_f32_32x32x16_bf16 v[96:111], v[80:83], v[84:87], v[96:111]
ds_read_b128 v[80:83], v10 offset:30720
ds_read_b128 v[84:87], v9 offset:30720
s_waitcnt lgkmcnt(6)
v_mfma_f32_32x32x16_bf16 v[96:111], v[88:91], v[92:95], v[96:111]
ds_read_b128 v[88:91], v10 offset:31744
ds_read_b128 v[92:95], v9 offset:31744
s_waitcnt lgkmcnt(6)
v_mfma_f32_32x32x16_bf16 v[96:111], v[64:67], v[68:71], v[96:111]
s_waitcnt lgkmcnt(4)
v_mfma_f32_32x32x16_bf16 v[96:111], v[72:75], v[76:79], v[96:111]
s_waitcnt lgkmcnt(2)
v_mfma_f32_32x32x16_bf16 v[96:111], v[80:83], v[84:87], v[96:111]
s_waitcnt lgkmcnt(0)
v_mfma_f32_32x32x16_bf16 v[96:111], v[88:91], v[92:95], v[96:111]
s_waitcnt vmcnt(0)
v_lshlrev_b32 v80, 16, v16
v_and_b32 v81, 0xffff0000, v16
v_lshlrev_b32 v82, 16, v17
v_and_b32 v83, 0xffff0000, v17
v_lshlrev_b32 v84, 16, v18
v_and_b32 v85, 0xffff0000, v18
v_lshlrev_b32 v86, 16, v19
v_and_b32 v87, 0xffff0000, v19
v_lshlrev_b32 v88, 16, v20
v_and_b32 v89, 0xffff0000, v20
v_lshlrev_b32 v90, 16, v21
v_and_b32 v91, 0xffff0000, v21
v_lshlrev_b32 v92, 16, v22
v_and_b32 v93, 0xffff0000, v22
v_lshlrev_b32 v94, 16, v23
v_and_b32 v95, 0xffff0000, v23
v_cvt_pk_bf16_f32 v64, v96, v97
v_cvt_pk_bf16_f32 v65, v98, v99
v_cvt_pk_bf16_f32 v66, v100, v101
v_cvt_pk_bf16_f32 v67, v102, v103
v_cvt_pk_bf16_f32 v68, v104, v105
v_cvt_pk_bf16_f32 v69, v106, v107
v_cvt_pk_bf16_f32 v70, v108, v109
v_cvt_pk_bf16_f32 v71, v110, v111
v_lshlrev_b32 v96, 16, v64
v_and_b32 v97, 0xffff0000, v64
v_lshlrev_b32 v98, 16, v65
v_and_b32 v99, 0xffff0000, v65
v_lshlrev_b32 v100, 16, v66
v_and_b32 v101, 0xffff0000, v66
v_lshlrev_b32 v102, 16, v67
v_and_b32 v103, 0xffff0000, v67
v_lshlrev_b32 v104, 16, v68
v_and_b32 v105, 0xffff0000, v68
v_lshlrev_b32 v106, 16, v69
v_and_b32 v107, 0xffff0000, v69
v_lshlrev_b32 v108, 16, v70
v_and_b32 v109, 0xffff0000, v70
v_lshlrev_b32 v110, 16, v71
v_and_b32 v111, 0xffff0000, v71
v_pk_mul_f32 v[96:97], v[96:97], v[24:25]
v_pk_mul_f32 v[98:99], v[98:99], v[26:27]
v_pk_mul_f32 v[100:101], v[100:101], v[28:29]
v_pk_mul_f32 v[102:103], v[102:103], v[30:31]
v_pk_mul_f32 v[104:105], v[104:105], v[32:33]
v_pk_mul_f32 v[106:107], v[106:107], v[34:35]
v_pk_mul_f32 v[108:109], v[108:109], v[36:37]
v_pk_mul_f32 v[110:111], v[110:111], v[38:39]
v_cvt_pk_bf16_f32 v64, v96, v97
v_cvt_pk_bf16_f32 v65, v98, v99
v_cvt_pk_bf16_f32 v66, v100, v101
v_cvt_pk_bf16_f32 v67, v102, v103
v_cvt_pk_bf16_f32 v68, v104, v105
v_cvt_pk_bf16_f32 v69, v106, v107
v_cvt_pk_bf16_f32 v70, v108, v109
v_cvt_pk_bf16_f32 v71, v110, v111
v_lshlrev_b32 v96, 16, v64
v_and_b32 v97, 0xffff0000, v64
v_lshlrev_b32 v98, 16, v65
v_and_b32 v99, 0xffff0000, v65
v_lshlrev_b32 v100, 16, v66
v_and_b32 v101, 0xffff0000, v66
v_lshlrev_b32 v102, 16, v67
v_and_b32 v103, 0xffff0000, v67
v_lshlrev_b32 v104, 16, v68
v_and_b32 v105, 0xffff0000, v68
v_lshlrev_b32 v106, 16, v69
v_and_b32 v107, 0xffff0000, v69
v_lshlrev_b32 v108, 16, v70
v_and_b32 v109, 0xffff0000, v70
v_lshlrev_b32 v110, 16, v71
v_and_b32 v111, 0xffff0000, v71
v_pk_add_f32 v[96:97], v[96:97], v[80:81]
v_pk_add_f32 v[98:99], v[98:99], v[82:83]
v_pk_add_f32 v[100:101], v[100:101], v[84:85]
v_pk_add_f32 v[102:103], v[102:103], v[86:87]
v_pk_add_f32 v[104:105], v[104:105], v[88:89]
v_pk_add_f32 v[106:107], v[106:107], v[90:91]
v_pk_add_f32 v[108:109], v[108:109], v[92:93]
v_pk_add_f32 v[110:111], v[110:111], v[94:95]
v_cvt_pk_bf16_f32 v64, v96, v97
v_cvt_pk_bf16_f32 v65, v98, v99
v_cvt_pk_bf16_f32 v66, v100, v101
v_cvt_pk_bf16_f32 v67, v102, v103
v_cvt_pk_bf16_f32 v68, v104, v105
v_cvt_pk_bf16_f32 v69, v106, v107
v_cvt_pk_bf16_f32 v70, v108, v109
v_cvt_pk_bf16_f32 v71, v110, v111
s_add_u32 s20, s4, 12582912
s_addc_u32 s21, s5, 0
global_store_dwordx4 v7, v[64:67], s[20:21]
global_store_dwordx4 v7, v[68:71], s[20:21] offset:16
v_lshlrev_b32 v96, 16, v64
v_and_b32 v97, 0xffff0000, v64
v_lshlrev_b32 v98, 16, v65
v_and_b32 v99, 0xffff0000, v65
v_lshlrev_b32 v100, 16, v66
v_and_b32 v101, 0xffff0000, v66
v_lshlrev_b32 v102, 16, v67
v_and_b32 v103, 0xffff0000, v67
v_lshlrev_b32 v104, 16, v68
v_and_b32 v105, 0xffff0000, v68
v_lshlrev_b32 v106, 16, v69
v_and_b32 v107, 0xffff0000, v69
v_lshlrev_b32 v108, 16, v70
v_and_b32 v109, 0xffff0000, v70
v_lshlrev_b32 v110, 16, v71
v_and_b32 v111, 0xffff0000, v71
v_pk_add_f32 v[80:81], v[96:97], v[98:99]
v_pk_mul_f32 v[82:83], v[96:97], v[96:97]
v_pk_mul_f32 v[84:85], v[96:97], v[40:41]
v_pk_fma_f32 v[82:83], v[98:99], v[98:99], v[82:83]
v_pk_fma_f32 v[84:85], v[98:99], v[42:43], v[84:85]
v_pk_add_f32 v[80:81], v[80:81], v[100:101]
v_pk_fma_f32 v[82:83], v[100:101], v[100:101], v[82:83]
v_pk_fma_f32 v[84:85], v[100:101], v[44:45], v[84:85]
v_pk_add_f32 v[80:81], v[80:81], v[102:103]
v_pk_fma_f32 v[82:83], v[102:103], v[102:103], v[82:83]
v_pk_fma_f32 v[84:85], v[102:103], v[46:47], v[84:85]
v_pk_add_f32 v[80:81], v[80:81], v[104:105]
v_pk_fma_f32 v[82:83], v[104:105], v[104:105], v[82:83]
v_pk_fma_f32 v[84:85], v[104:105], v[48:49], v[84:85]
v_pk_add_f32 v[80:81], v[80:81], v[106:107]
v_pk_fma_f32 v[82:83], v[106:107], v[106:107], v[82:83]
v_pk_fma_f32 v[84:85], v[106:107], v[50:51], v[84:85]
v_pk_add_f32 v[80:81], v[80:81], v[108:109]
v_pk_fma_f32 v[82:83], v[108:109], v[108:109], v[82:83]
v_pk_fma_f32 v[84:85], v[108:109], v[52:53], v[84:85]
v_pk_add_f32 v[80:81], v[80:81], v[110:111]
v_pk_fma_f32 v[82:83], v[110:111], v[110:111], v[82:83]
v_pk_fma_f32 v[84:85], v[110:111], v[54:55], v[84:85]
v_add_f32 v80, v80, v81
v_mov_b32 v81, v80
s_nop 1
v_permlane32_swap_b32 v80, v81
v_add_f32 v80, v80, v81
v_add_f32 v82, v82, v83
v_mov_b32 v83, v82
s_nop 1
v_permlane32_swap_b32 v82, v83
v_add_f32 v82, v82, v83
v_add_f32 v84, v84, v85
v_mov_b32 v85, v84
s_nop 1
v_permlane32_swap_b32 v84, v85
v_add_f32 v84, v84, v85
s_mul_i32 s18, s12, 768
s_lshl_b32 s19, s11, 7
s_add_u32 s18, s18, s19
s_add_u32 s18, s18, 131072
v_lshlrev_b32 v3, 2, v3
v_add_u32 v3, s18, v3
ds_write_b32 v3, v80
ds_write_b32 v3, v82 offset:256
ds_write_b32 v3, v84 offset:512
s_lshl_b32 s18, s10, 8
s_add_u32 s18, s18, 131072
v_lshlrev_b32 v4, 2, v1
v_add_u32 v5, s18, v4
s_lshl_b32 s18, s10, 13
s_lshl_b32 s19, s8, 8
s_add_u32 s18, s18, s19
s_add_u32 s18, s18, 15269888
s_add_u32 s4, s4, s18
s_addc_u32 s5, s5, 0
s_waitcnt lgkmcnt(0)
s_barrier
s_cmp_ge_u32 s10, 3
s_cbranch_scc1 K2_END
ds_read_b32 v6, v5
ds_read_b32 v7, v5 offset:768
s_waitcnt lgkmcnt(0)
v_add_f32 v6, v6, v7
global_atomic_add_f32 v4, v6, s[4:5]
K2_END:
s_endpgm
.globl k4_kernel
.p2align 8
.type k4_kernel,@function
k4_kernel:
s_cmp_ge_u32 s2, 214
s_cbranch_scc1 K4_END
s_load_dwordx2 s[4:5], s[0:1], 96
s_cmp_ge_u32 s2, 86
s_cbranch_scc1 K4_OUT
s_load_dwordx2 s[6:7], s[0:1], 40
s_load_dwordx2 s[8:9], s[0:1], 48
s_load_dwordx2 s[10:11], s[0:1], 32
v_lshrrev_b32 v1, 2, v0
v_mul_u32_u24 v1, 2752, v1
v_and_b32 v2, 1, v0
v_lshlrev_b32 v2, 4, v2
v_add_u32 v1, v1, v2
s_lshl_b32 s12, s2, 5
v_add_u32 v1, s12, v1
v_lshlrev_b32 v3, 5, v0
v_lshlrev_b32 v4, 3, v0
v_lshlrev_b32 v5, 2, v0
s_waitcnt lgkmcnt(0)
s_add_u32 s14, s4, 15269888
s_addc_u32 s15, s5, 0
s_add_u32 s16, s4, 15278080
s_addc_u32 s17, s5, 0
s_add_u32 s18, s4, 15286272
s_addc_u32 s19, s5, 0
s_add_u32 s20, s4, 15204352
s_addc_u32 s21, s5, 0
global_load_dwordx2 v[40:41], v4, s[20:21] offset:2048
v_add_u32 v6, 4096, v4
global_load_dwordx2 v[42:43], v6, s[20:21]
v_add_u32 v7, 8192, v4
global_load_dwordx2 v[44:45], v7, s[20:21]
global_load_dword v46, v5, s[10:11]
global_load_dwordx4 v[16:19], v3, s[14:15]
global_load_dwordx4 v[20:23], v3, s[14:15] offset:16
global_load_dwordx4 v[24:27], v3, s[16:17]
global_load_dwordx4 v[28:31], v3, s[16:17] offset:16
global_load_dwordx4 v[32:35], v3, s[18:19]
global_load_dwordx4 v[36:39], v3, s[18:19] offset:16
v_and_b32 v2, 2, v0
v_cmp_eq_u32 vcc, 0, v2
v_mov_b32 v8, s8
v_mov_b32 v9, s9
v_mov_b32 v10, s6
v_mov_b32 v11, s7
v_cndmask_b32 v8, v8, v10, vcc
v_cndmask_b32 v9, v9, v11, vcc
v_add_co_u32 v8, vcc, v8, v1
s_nop 1
v_addc_co_u32 v9, vcc, 0, v9, vcc
global_load_dwordx4 v[64:67], v[8:9], off
v_add_co_u32 v8, vcc, 176128, v8
s_nop 1
v_addc_co_u32 v9, vcc, 0, v9, vcc
global_load_dwordx4 v[68:71], v[8:9], off
v_add_co_u32 v8, vcc, 176128, v8
s_nop 1
v_addc_co_u32 v9, vcc, 0, v9, vcc
global_load_dwordx4 v[72:75], v[8:9], off
v_add_co_u32 v8, vcc, 176128, v8
s_nop 1
v_addc_co_u32 v9, vcc, 0, v9, vcc
global_load_dwordx4 v[76:79], v[8:9], off
v_add_co_u32 v8, vcc, 176128, v8
s_nop 1
v_addc_co_u32 v9, vcc, 0, v9, vcc
global_load_dwordx4 v[80:83], v[8:9], off
v_add_co_u32 v8, vcc, 176128, v8
s_nop 1
v_addc_co_u32 v9, vcc, 0, v9, vcc
global_load_dwordx4 v[84:87], v[8:9], off
v_add_co_u32 v8, vcc, 176128, v8
s_nop 1
v_addc_co_u32 v9, vcc, 0, v9, vcc
global_load_dwordx4 v[88:91], v[8:9], off
v_add_co_u32 v8, vcc, 176128, v8
s_nop 1
v_addc_co_u32 v9, vcc, 0, v9, vcc
global_load_dwordx4 v[92:95], v[8:9], off
s_waitcnt vmcnt(14)
v_lshlrev_b32 v47, 16, v46
v_and_b32 v48, 0xffff0000, v46
v_mul_f32 v47, v47, v40
v_fmac_f32 v47, v48, v41
v_add_f32 v48, v44, v45
s_nop 0
v_add_f32_dpp v47, v47, v47 quad_perm:[1,0,3,2] row_mask:0xf bank_mask:0xf
s_nop 1
v_add_f32_dpp v47, v47, v47 quad_perm:[2,3,0,1] row_mask:0xf bank_mask:0xf
s_nop 1
v_add_f32_dpp v47, v47, v47 row_half_mirror row_mask:0xf bank_mask:0xf
s_nop 1
v_add_f32_dpp v47, v47, v47 row_mirror row_mask:0xf bank_mask:0xf
v_mov_b32 v49, v47
s_nop 1
v_permlane16_swap_b32 v47, v49
v_add_f32 v47, v47, v49
v_mov_b32 v49, v47
s_nop 1
v_permlane32_swap_b32 v47, v49
v_add_f32 v47, v47, v49
v_add_f32_dpp v48, v48, v48 quad_perm:[1,0,3,2] row_mask:0xf bank_mask:0xf
s_nop 1
v_add_f32_dpp v48, v48, v48 quad_perm:[2,3,0,1] row_mask:0xf bank_mask:0xf
s_nop 1
v_add_f32_dpp v48, v48, v48 row_half_mirror row_mask:0xf bank_mask:0xf
s_nop 1
v_add_f32_dpp v48, v48, v48 row_mirror row_mask:0xf bank_mask:0xf
v_mov_b32 v49, v48
s_nop 1
v_permlane16_swap_b32 v48, v49
v_add_f32 v48, v48, v49
v_mov_b32 v49, v48
s_nop 1
v_permlane32_swap_b32 v48, v49
v_add_f32 v48, v48, v49
v_lshrrev_b32 v12, 6, v0
v_lshlrev_b32 v13, 3, v12
v_mov_b32 v50, v47
v_mov_b32 v51, v48
ds_write_b64 v13, v[50:51]
ds_write_b64 v4, v[40:41] offset:1024
ds_write_b64 v4, v[42:43] offset:3072
v_mov_b32 v13, 0
s_waitcnt lgkmcnt(0)
s_barrier
ds_read_b128 v[52:55], v13
ds_read_b128 v[56:59], v13 offset:16
s_waitcnt lgkmcnt(0)
v_add_f32 v52, v52, v54
v_add_f32 v56, v56, v58
v_add_f32 v52, v52, v56
v_add_f32 v53, v53, v55
v_add_f32 v57, v57, v59
v_add_f32 v53, v53, v57
s_waitcnt vmcnt(8)
v_mov_b32 v54, 0
v_mov_b32 v55, 0
v_lshlrev_b32 v12, 3, v0
v_sub_u32 v12, 0x7ff, v12
v_mul_f32 v56, 0x3b000000, v16
v_mul_f32 v58, v56, v56
v_mul_f32 v57, 0x3b000000, v24
v_sub_f32 v57, v57, v58
v_max_f32 v57, 0, v57
v_add_f32 v57, 0x3727c5ac, v57
v_rsq_f32 v57, v57
v_fma_f32 v58, -v56, v53, v32
v_fma_f32 v58, v57, v58, v52
v_cvt_pk_bf16_f32 v58, v58, v58
v_and_b32 v58, 0xffff, v58
v_bfe_i32 v59, v58, 15, 1
v_or_b32 v59, 0x8000, v59
v_xor_b32 v58, v58, v59
v_lshlrev_b32 v58, 16, v58
v_subrev_u32 v59, 0, v12
v_or_b32 v58, v58, v59
v_med3_u32 v55, v54, v55, v58
v_max_u32 v54, v54, v58
v_mul_f32 v56, 0x3b000000, v17
v_mul_f32 v58, v56, v56
v_mul_f32 v57, 0x3b000000, v25
v_sub_f32 v57, v57, v58
v_max_f32 v57, 0, v57
v_add_f32 v57, 0x3727c5ac, v57
v_rsq_f32 v57, v57
v_fma_f32 v58, -v56, v53, v33
v_fma_f32 v58, v57, v58, v52
v_cvt_pk_bf16_f32 v58, v58, v58
v_and_b32 v58, 0xffff, v58
v_bfe_i32 v59, v58, 15, 1
v_or_b32 v59, 0x8000, v59
v_xor_b32 v58, v58, v59
v_lshlrev_b32 v58, 16, v58
v_subrev_u32 v59, 1, v12
v_or_b32 v58, v58, v59
v_med3_u32 v55, v54, v55, v58
v_max_u32 v54, v54, v58
v_mul_f32 v56, 0x3b000000, v18
v_mul_f32 v58, v56, v56
v_mul_f32 v57, 0x3b000000, v26
v_sub_f32 v57, v57, v58
v_max_f32 v57, 0, v57
v_add_f32 v57, 0x3727c5ac, v57
v_rsq_f32 v57, v57
v_fma_f32 v58, -v56, v53, v34
v_fma_f32 v58, v57, v58, v52
v_cvt_pk_bf16_f32 v58, v58, v58
v_and_b32 v58, 0xffff, v58
v_bfe_i32 v59, v58, 15, 1
v_or_b32 v59, 0x8000, v59
v_xor_b32 v58, v58, v59
v_lshlrev_b32 v58, 16, v58
v_subrev_u32 v59, 2, v12
v_or_b32 v58, v58, v59
v_med3_u32 v55, v54, v55, v58
v_max_u32 v54, v54, v58
v_mul_f32 v56, 0x3b000000, v19
v_mul_f32 v58, v56, v56
v_mul_f32 v57, 0x3b000000, v27
v_sub_f32 v57, v57, v58
v_max_f32 v57, 0, v57
v_add_f32 v57, 0x3727c5ac, v57
v_rsq_f32 v57, v57
v_fma_f32 v58, -v56, v53, v35
v_fma_f32 v58, v57, v58, v52
v_cvt_pk_bf16_f32 v58, v58, v58
v_and_b32 v58, 0xffff, v58
v_bfe_i32 v59, v58, 15, 1
v_or_b32 v59, 0x8000, v59
v_xor_b32 v58, v58, v59
v_lshlrev_b32 v58, 16, v58
v_subrev_u32 v59, 3, v12
v_or_b32 v58, v58, v59
v_med3_u32 v55, v54, v55, v58
v_max_u32 v54, v54, v58
v_mul_f32 v56, 0x3b000000, v20
v_mul_f32 v58, v56, v56
v_mul_f32 v57, 0x3b000000, v28
v_sub_f32 v57, v57, v58
v_max_f32 v57, 0, v57
v_add_f32 v57, 0x3727c5ac, v57
v_rsq_f32 v57, v57
v_fma_f32 v58, -v56, v53, v36
v_fma_f32 v58, v57, v58, v52
v_cvt_pk_bf16_f32 v58, v58, v58
v_and_b32 v58, 0xffff, v58
v_bfe_i32 v59, v58, 15, 1
v_or_b32 v59, 0x8000, v59
v_xor_b32 v58, v58, v59
v_lshlrev_b32 v58, 16, v58
v_subrev_u32 v59, 4, v12
v_or_b32 v58, v58, v59
v_med3_u32 v55, v54, v55, v58
v_max_u32 v54, v54, v58
v_mul_f32 v56, 0x3b000000, v21
v_mul_f32 v58, v56, v56
v_mul_f32 v57, 0x3b000000, v29
v_sub_f32 v57, v57, v58
v_max_f32 v57, 0, v57
v_add_f32 v57, 0x3727c5ac, v57
v_rsq_f32 v57, v57
v_fma_f32 v58, -v56, v53, v37
v_fma_f32 v58, v57, v58, v52
v_cvt_pk_bf16_f32 v58, v58, v58
v_and_b32 v58, 0xffff, v58
v_bfe_i32 v59, v58, 15, 1
v_or_b32 v59, 0x8000, v59
v_xor_b32 v58, v58, v59
v_lshlrev_b32 v58, 16, v58
v_subrev_u32 v59, 5, v12
v_or_b32 v58, v58, v59
v_med3_u32 v55, v54, v55, v58
v_max_u32 v54, v54, v58
v_mul_f32 v56, 0x3b000000, v22
v_mul_f32 v58, v56, v56
v_mul_f32 v57, 0x3b000000, v30
v_sub_f32 v57, v57, v58
v_max_f32 v57, 0, v57
v_add_f32 v57, 0x3727c5ac, v57
v_rsq_f32 v57, v57
v_fma_f32 v58, -v56, v53, v38
v_fma_f32 v58, v57, v58, v52
v_cvt_pk_bf16_f32 v58, v58, v58
v_and_b32 v58, 0xffff, v58
v_bfe_i32 v59, v58, 15, 1
v_or_b32 v59, 0x8000, v59
v_xor_b32 v58, v58, v59
v_lshlrev_b32 v58, 16, v58
v_subrev_u32 v59, 6, v12
v_or_b32 v58, v58, v59
v_med3_u32 v55, v54, v55, v58
v_max_u32 v54, v54, v58
v_mul_f32 v56, 0x3b000000, v23
v_mul_f32 v58, v56, v56
v_mul_f32 v57, 0x3b000000, v31
v_sub_f32 v57, v57, v58
v_max_f32 v57, 0, v57
v_add_f32 v57, 0x3727c5ac, v57
v_rsq_f32 v57, v57
v_fma_f32 v58, -v56, v53, v39
v_fma_f32 v58, v57, v58, v52
v_cvt_pk_bf16_f32 v58, v58, v58
v_and_b32 v58, 0xffff, v58
v_bfe_i32 v59, v58, 15, 1
v_or_b32 v59, 0x8000, v59
v_xor_b32 v58, v58, v59
v_lshlrev_b32 v58, 16, v58
v_subrev_u32 v59, 7, v12
v_or_b32 v58, v58, v59
v_med3_u32 v55, v54, v55, v58
v_max_u32 v54, v54, v58
s_nop 1
v_mov_b32_dpp v56, v54 quad_perm:[1,0,3,2] row_mask:0xf bank_mask:0xf
v_mov_b32_dpp v57, v55 quad_perm:[1,0,3,2] row_mask:0xf bank_mask:0xf
v_min_u32 v58, v54, v56
v_max_u32 v54, v54, v56
v_max3_u32 v55, v58, v55, v57
s_nop 0
v_mov_b32_dpp v56, v54 quad_perm:[2,3,0,1] row_mask:0xf bank_mask:0xf
s_nop 0
v_mov_b32_dpp v57, v55 quad_perm:[2,3,0,1] row_mask:0xf bank_mask:0xf
v_min_u32 v58, v54, v56
v_max_u32 v54, v54, v56
v_max3_u32 v55, v58, v55, v57
s_nop 0
v_mov_b32_dpp v56, v54 row_half_mirror row_mask:0xf bank_mask:0xf
s_nop 0
v_mov_b32_dpp v57, v55 row_half_mirror row_mask:0xf bank_mask:0xf
v_min_u32 v58, v54, v56
v_max_u32 v54, v54, v56
v_max3_u32 v55, v58, v55, v57
s_nop 0
v_mov_b32_dpp v56, v54 row_mirror row_mask:0xf bank_mask:0xf
s_nop 0
v_mov_b32_dpp v57, v55 row_mirror row_mask:0xf bank_mask:0xf
v_min_u32 v58, v54, v56
v_max_u32 v54, v54, v56
v_max3_u32 v55, v58, v55, v57
v_mov_b32 v56, v54
v_mov_b32 v57, v55
s_nop 0
v_permlane16_swap_b32 v54, v56
s_nop 0
v_permlane16_swap_b32 v55, v57
v_min_u32 v58, v54, v56
v_max_u32 v54, v54, v56
v_max3_u32 v55, v58, v55, v57
v_mov_b32 v56, v54
v_mov_b32 v57, v55
s_nop 0
v_permlane32_swap_b32 v54, v56
s_nop 0
v_permlane32_swap_b32 v55, v57
v_min_u32 v58, v54, v56
v_max_u32 v54, v54, v56
v_max3_u32 v55, v58, v55, v57
v_lshrrev_b32 v12, 6, v0
v_lshlrev_b32 v13, 3, v12
ds_write_b64 v13, v[54:55] offset:64
v_mov_b32 v13, 0
s_waitcnt lgkmcnt(0)
s_barrier
ds_read_b128 v[56:59], v13 offset:64
ds_read_b128 v[60:63], v13 offset:80
s_waitcnt lgkmcnt(0)
v_min_u32 v12, v56, v58
v_max_u32 v56, v56, v58
v_max3_u32 v57, v12, v57, v59
v_min_u32 v12, v60, v62
v_max_u32 v60, v60, v62
v_max3_u32 v61, v12, v61, v63
v_min_u32 v12, v56, v60
v_max_u32 v56, v56, v60
v_max3_u32 v57, v12, v57, v61
v_readfirstlane_b32 s22, v56
v_readfirstlane_b32 s23, v57
v_readfirstlane_b32 s24, v0
s_nop 3
s_lshr_b32 s24, s24, 6
s_nop 0
s_and_b32 s25, s22, 0x7ff
s_sub_u32 s25, 0x7ff, s25
s_and_b32 s26, s23, 0x7ff
s_sub_u32 s26, 0x7ff, s26
s_cmp_ge_u32 s24, 2
s_cbranch_scc1 K4_PUB
s_cmp_eq_u32 s24, 0
s_cselect_b32 s27, s25, s26
s_cselect_b32 s28, s22, s23
v_and_b32 v12, 63, v0
v_lshlrev_b32 v13, 4, v12
s_lshl_b32 s29, s27, 10
s_add_u32 s29, s29, 12582912
s_add_u32 s30, s4, s29
s_addc_u32 s31, s5, 0
global_load_dwordx4 v[16:19], v13, s[30:31]
s_lshl_b32 s29, s27, 2
v_mov_b32 v14, s29
global_load_dword v20, v14, s[14:15]
global_load_dword v21, v14, s[16:17]
v_lshlrev_b32 v14, 5, v12
ds_read_b128 v[32:35], v14 offset:1024
ds_read_b128 v[36:39], v14 offset:1040
ds_read_b128 v[40:43], v14 offset:3072
ds_read_b128 v[44:47], v14 offset:3088
s_waitcnt vmcnt(0) lgkmcnt(0)
v_mul_f32 v22, 0x3b000000, v20
v_mul_f32 v23, v22, v22
v_mul_f32 v24, 0x3b000000, v21
v_sub_f32 v24, v24, v23
v_max_f32 v24, 0, v24
v_add_f32 v24, 0x3727c5ac, v24
v_rsq_f32 v24, v24
v_lshlrev_b32 v48, 16, v16
v_and_b32 v49, 0xffff0000, v16
v_lshlrev_b32 v50, 16, v17
v_and_b32 v51, 0xffff0000, v17
v_lshlrev_b32 v52, 16, v18
v_and_b32 v53, 0xffff0000, v18
v_lshlrev_b32 v54, 16, v19
v_and_b32 v55, 0xffff0000, v19
v_pk_add_f32 v[48:49], v[48:49], v[22:23] op_sel_hi:[1,0] neg_lo:[0,1] neg_hi:[0,1]
v_pk_add_f32 v[50:51], v[50:51], v[22:23] op_sel_hi:[1,0] neg_lo:[0,1] neg_hi:[0,1]
v_pk_add_f32 v[52:53], v[52:53], v[22:23] op_sel_hi:[1,0] neg_lo:[0,1] neg_hi:[0,1]
v_pk_add_f32 v[54:55], v[54:55], v[22:23] op_sel_hi:[1,0] neg_lo:[0,1] neg_hi:[0,1]
v_pk_mul_f32 v[48:49], v[48:49], v[24:25] op_sel_hi:[1,0]
v_pk_mul_f32 v[50:51], v[50:51], v[24:25] op_sel_hi:[1,0]
v_pk_mul_f32 v[52:53], v[52:53], v[24:25] op_sel_hi:[1,0]
v_pk_mul_f32 v[54:55], v[54:55], v[24:25] op_sel_hi:[1,0]
v_cvt_pk_bf16_f32 v26, v48, v49
v_cvt_pk_bf16_f32 v27, v50, v51
v_cvt_pk_bf16_f32 v28, v52, v53
v_cvt_pk_bf16_f32 v29, v54, v55
v_lshlrev_b32 v48, 16, v26
v_and_b32 v49, 0xffff0000, v26
v_lshlrev_b32 v50, 16, v27
v_and_b32 v51, 0xffff0000, v27
v_lshlrev_b32 v52, 16, v28
v_and_b32 v53, 0xffff0000, v28
v_lshlrev_b32 v54, 16, v29
v_and_b32 v55, 0xffff0000, v29
v_pk_mul_f32 v[48:49], v[48:49], v[40:41]
v_pk_mul_f32 v[50:51], v[50:51], v[42:43]
v_pk_mul_f32 v[52:53], v[52:53], v[44:45]
v_pk_mul_f32 v[54:55], v[54:55], v[46:47]
v_cvt_pk_bf16_f32 v26, v48, v49
v_cvt_pk_bf16_f32 v27, v50, v51
v_cvt_pk_bf16_f32 v28, v52, v53
v_cvt_pk_bf16_f32 v29, v54, v55
v_lshlrev_b32 v48, 16, v26
v_and_b32 v49, 0xffff0000, v26
v_lshlrev_b32 v50, 16, v27
v_and_b32 v51, 0xffff0000, v27
v_lshlrev_b32 v52, 16, v28
v_and_b32 v53, 0xffff0000, v28
v_lshlrev_b32 v54, 16, v29
v_and_b32 v55, 0xffff0000, v29
v_pk_add_f32 v[48:49], v[48:49], v[32:33]
v_pk_add_f32 v[50:51], v[50:51], v[34:35]
v_pk_add_f32 v[52:53], v[52:53], v[36:37]
v_pk_add_f32 v[54:55], v[54:55], v[38:39]
v_cvt_pk_bf16_f32 v26, v48, v49
v_cvt_pk_bf16_f32 v27, v50, v51
v_cvt_pk_bf16_f32 v28, v52, v53
v_cvt_pk_bf16_f32 v29, v54, v55
v_lshlrev_b32 v48, 16, v26
v_and_b32 v49, 0xffff0000, v26
v_lshlrev_b32 v50, 16, v27
v_and_b32 v51, 0xffff0000, v27
v_lshlrev_b32 v52, 16, v28
v_and_b32 v53, 0xffff0000, v28
v_lshlrev_b32 v54, 16, v29
v_and_b32 v55, 0xffff0000, v29
s_lshl_b32 s29, s24, 2
v_lshlrev_b32 v15, 6, v12
v_add_u32 v15, s29, v15
ds_write_b32 v15, v48 offset:8192
ds_write_b32 v15, v49 offset:8200
ds_write_b32 v15, v50 offset:8208
ds_write_b32 v15, v51 offset:8216
ds_write_b32 v15, v52 offset:8224
ds_write_b32 v15, v53 offset:8232
ds_write_b32 v15, v54 offset:8240
ds_write_b32 v15, v55 offset:8248
s_branch K4_H2DONE
K4_PUB:
s_cmp_ge_u32 s2, 32
s_cbranch_scc1 K4_H2DONE
s_cmp_eq_u32 s24, 2
s_cselect_b32 s27, s25, s26
s_cselect_b32 s28, s22, s23
s_lshr_b32 s28, s28, 16
s_and_b32 s29, s28, 0x8000
s_cmp_lg_u32 s29, 0
s_mov_b32 s33, 0xffff
s_cselect_b32 s29, 0x8000, s33
s_xor_b32 s28, s28, s29
s_lshl_b32 s28, s28, 16
v_mov_b32 v60, s28
v_mul_f32 v60, 0xbfb8aa3b, v60
v_exp_f32 v60, v60
s_nop 0
v_add_f32 v60, 1.0, v60
v_rcp_f32 v60, v60
s_nop 0
v_cvt_pk_bf16_f32 v60, v60, v60
v_lshlrev_b32 v60, 16, v60
v_or_b32 v61, 1, v60
s_add_u32 s29, s27, 1
v_mov_b32 v60, s29
s_and_b32 s29, s24, 1
s_lshl_b32 s29, s29, 3
s_lshl_b32 s33, s2, 7
s_add_u32 s29, s29, s33
v_mov_b32 v62, s29
s_add_u32 s34, s4, 15305728
s_addc_u32 s35, s5, 0
s_mov_b64 exec, 1
global_store_dwordx2 v62, v[60:61], s[34:35] sc1
s_mov_b64 exec, -1
K4_H2DONE:
s_waitcnt lgkmcnt(0)
s_barrier
v_lshrrev_b32 v12, 2, v0
v_lshlrev_b32 v12, 3, v12
ds_read_b64 v[16:17], v12 offset:8192
ds_read_b64 v[18:19], v12 offset:8704
ds_read_b64 v[20:21], v12 offset:9216
ds_read_b64 v[22:23], v12 offset:9728
ds_read_b64 v[24:25], v12 offset:10240
ds_read_b64 v[26:27], v12 offset:10752
ds_read_b64 v[28:29], v12 offset:11264
ds_read_b64 v[30:31], v12 offset:11776
v_mov_b32 v32, 0
v_mov_b32 v33, 0
v_mov_b32 v34, 0
v_mov_b32 v35, 0
v_mov_b32 v36, 0
v_mov_b32 v37, 0
v_mov_b32 v38, 0
v_mov_b32 v39, 0
v_mov_b32 v40, 0
v_mov_b32 v41, 0
v_mov_b32 v42, 0
v_mov_b32 v43, 0
v_mov_b32 v44, 0
v_mov_b32 v45, 0
v_mov_b32 v46, 0
v_mov_b32 v47, 0
s_waitcnt vmcnt(0) lgkmcnt(0)
v_lshlrev_b32 v48, 16, v64
v_and_b32 v49, 0xffff0000, v64
v_pk_fma_f32 v[32:33], v[48:49], v[16:17], v[32:33] op_sel_hi:[0,1,1]
v_pk_fma_f32 v[34:35], v[48:49], v[16:17], v[34:35] op_sel:[1,0,0] op_sel_hi:[1,1,1]
v_lshlrev_b32 v50, 16, v65
v_and_b32 v51, 0xffff0000, v65
v_pk_fma_f32 v[36:37], v[50:51], v[16:17], v[36:37] op_sel_hi:[0,1,1]
v_pk_fma_f32 v[38:39], v[50:51], v[16:17], v[38:39] op_sel:[1,0,0] op_sel_hi:[1,1,1]
v_lshlrev_b32 v52, 16, v66
v_and_b32 v53, 0xffff0000, v66
v_pk_fma_f32 v[40:41], v[52:53], v[16:17], v[40:41] op_sel_hi:[0,1,1]
v_pk_fma_f32 v[42:43], v[52:53], v[16:17], v[42:43] op_sel:[1,0,0] op_sel_hi:[1,1,1]
v_lshlrev_b32 v54, 16, v67
v_and_b32 v55, 0xffff0000, v67
v_pk_fma_f32 v[44:45], v[54:55], v[16:17], v[44:45] op_sel_hi:[0,1,1]
v_pk_fma_f32 v[46:47], v[54:55], v[16:17], v[46:47] op_sel:[1,0,0] op_sel_hi:[1,1,1]
v_lshlrev_b32 v48, 16, v68
v_and_b32 v49, 0xffff0000, v68
v_pk_fma_f32 v[32:33], v[48:49], v[18:19], v[32:33] op_sel_hi:[0,1,1]
v_pk_fma_f32 v[34:35], v[48:49], v[18:19], v[34:35] op_sel:[1,0,0] op_sel_hi:[1,1,1]
v_lshlrev_b32 v50, 16, v69
v_and_b32 v51, 0xffff0000, v69
v_pk_fma_f32 v[36:37], v[50:51], v[18:19], v[36:37] op_sel_hi:[0,1,1]
v_pk_fma_f32 v[38:39], v[50:51], v[18:19], v[38:39] op_sel:[1,0,0] op_sel_hi:[1,1,1]
v_lshlrev_b32 v52, 16, v70
v_and_b32 v53, 0xffff0000, v70
v_pk_fma_f32 v[40:41], v[52:53], v[18:19], v[40:41] op_sel_hi:[0,1,1]
v_pk_fma_f32 v[42:43], v[52:53], v[18:19], v[42:43] op_sel:[1,0,0] op_sel_hi:[1,1,1]
v_lshlrev_b32 v54, 16, v71
v_and_b32 v55, 0xffff0000, v71
v_pk_fma_f32 v[44:45], v[54:55], v[18:19], v[44:45] op_sel_hi:[0,1,1]
v_pk_fma_f32 v[46:47], v[54:55], v[18:19], v[46:47] op_sel:[1,0,0] op_sel_hi:[1,1,1]
v_lshlrev_b32 v48, 16, v72
v_and_b32 v49, 0xffff0000, v72
v_pk_fma_f32 v[32:33], v[48:49], v[20:21], v[32:33] op_sel_hi:[0,1,1]
v_pk_fma_f32 v[34:35], v[48:49], v[20:21], v[34:35] op_sel:[1,0,0] op_sel_hi:[1,1,1]
v_lshlrev_b32 v50, 16, v73
v_and_b32 v51, 0xffff0000, v73
v_pk_fma_f32 v[36:37], v[50:51], v[20:21], v[36:37] op_sel_hi:[0,1,1]
v_pk_fma_f32 v[38:39], v[50:51], v[20:21], v[38:39] op_sel:[1,0,0] op_sel_hi:[1,1,1]
v_lshlrev_b32 v52, 16, v74
v_and_b32 v53, 0xffff0000, v74
v_pk_fma_f32 v[40:41], v[52:53], v[20:21], v[40:41] op_sel_hi:[0,1,1]
v_pk_fma_f32 v[42:43], v[52:53], v[20:21], v[42:43] op_sel:[1,0,0] op_sel_hi:[1,1,1]
v_lshlrev_b32 v54, 16, v75
v_and_b32 v55, 0xffff0000, v75
v_pk_fma_f32 v[44:45], v[54:55], v[20:21], v[44:45] op_sel_hi:[0,1,1]
v_pk_fma_f32 v[46:47], v[54:55], v[20:21], v[46:47] op_sel:[1,0,0] op_sel_hi:[1,1,1]
v_lshlrev_b32 v48, 16, v76
v_and_b32 v49, 0xffff0000, v76
v_pk_fma_f32 v[32:33], v[48:49], v[22:23], v[32:33] op_sel_hi:[0,1,1]
v_pk_fma_f32 v[34:35], v[48:49], v[22:23], v[34:35] op_sel:[1,0,0] op_sel_hi:[1,1,1]
v_lshlrev_b32 v50, 16, v77
v_and_b32 v51, 0xffff0000, v77
v_pk_fma_f32 v[36:37], v[50:51], v[22:23], v[36:37] op_sel_hi:[0,1,1]
v_pk_fma_f32 v[38:39], v[50:51], v[22:23], v[38:39] op_sel:[1,0,0] op_sel_hi:[1,1,1]
v_lshlrev_b32 v52, 16, v78
v_and_b32 v53, 0xffff0000, v78
v_pk_fma_f32 v[40:41], v[52:53], v[22:23], v[40:41] op_sel_hi:[0,1,1]
v_pk_fma_f32 v[42:43], v[52:53], v[22:23], v[42:43] op_sel:[1,0,0] op_sel_hi:[1,1,1]
v_lshlrev_b32 v54, 16, v79
v_and_b32 v55, 0xffff0000, v79
v_pk_fma_f32 v[44:45], v[54:55], v[22:23], v[44:45] op_sel_hi:[0,1,1]
v_pk_fma_f32 v[46:47], v[54:55], v[22:23], v[46:47] op_sel:[1,0,0] op_sel_hi:[1,1,1]
v_lshlrev_b32 v48, 16, v80
v_and_b32 v49, 0xffff0000, v80
v_pk_fma_f32 v[32:33], v[48:49], v[24:25], v[32:33] op_sel_hi:[0,1,1]
v_pk_fma_f32 v[34:35], v[48:49], v[24:25], v[34:35] op_sel:[1,0,0] op_sel_hi:[1,1,1]
v_lshlrev_b32 v50, 16, v81
v_and_b32 v51, 0xffff0000, v81
v_pk_fma_f32 v[36:37], v[50:51], v[24:25], v[36:37] op_sel_hi:[0,1,1]
v_pk_fma_f32 v[38:39], v[50:51], v[24:25], v[38:39] op_sel:[1,0,0] op_sel_hi:[1,1,1]
v_lshlrev_b32 v52, 16, v82
v_and_b32 v53, 0xffff0000, v82
v_pk_fma_f32 v[40:41], v[52:53], v[24:25], v[40:41] op_sel_hi:[0,1,1]
v_pk_fma_f32 v[42:43], v[52:53], v[24:25], v[42:43] op_sel:[1,0,0] op_sel_hi:[1,1,1]
v_lshlrev_b32 v54, 16, v83
v_and_b32 v55, 0xffff0000, v83
v_pk_fma_f32 v[44:45], v[54:55], v[24:25], v[44:45] op_sel_hi:[0,1,1]
v_pk_fma_f32 v[46:47], v[54:55], v[24:25], v[46:47] op_sel:[1,0,0] op_sel_hi:[1,1,1]
v_lshlrev_b32 v48, 16, v84
v_and_b32 v49, 0xffff0000, v84
v_pk_fma_f32 v[32:33], v[48:49], v[26:27], v[32:33] op_sel_hi:[0,1,1]
v_pk_fma_f32 v[34:35], v[48:49], v[26:27], v[34:35] op_sel:[1,0,0] op_sel_hi:[1,1,1]
v_lshlrev_b32 v50, 16, v85
v_and_b32 v51, 0xffff0000, v85
v_pk_fma_f32 v[36:37], v[50:51], v[26:27], v[36:37] op_sel_hi:[0,1,1]
v_pk_fma_f32 v[38:39], v[50:51], v[26:27], v[38:39] op_sel:[1,0,0] op_sel_hi:[1,1,1]
v_lshlrev_b32 v52, 16, v86
v_and_b32 v53, 0xffff0000, v86
v_pk_fma_f32 v[40:41], v[52:53], v[26:27], v[40:41] op_sel_hi:[0,1,1]
v_pk_fma_f32 v[42:43], v[52:53], v[26:27], v[42:43] op_sel:[1,0,0] op_sel_hi:[1,1,1]
v_lshlrev_b32 v54, 16, v87
v_and_b32 v55, 0xffff0000, v87
v_pk_fma_f32 v[44:45], v[54:55], v[26:27], v[44:45] op_sel_hi:[0,1,1]
v_pk_fma_f32 v[46:47], v[54:55], v[26:27], v[46:47] op_sel:[1,0,0] op_sel_hi:[1,1,1]
v_lshlrev_b32 v48, 16, v88
v_and_b32 v49, 0xffff0000, v88
v_pk_fma_f32 v[32:33], v[48:49], v[28:29], v[32:33] op_sel_hi:[0,1,1]
v_pk_fma_f32 v[34:35], v[48:49], v[28:29], v[34:35] op_sel:[1,0,0] op_sel_hi:[1,1,1]
v_lshlrev_b32 v50, 16, v89
v_and_b32 v51, 0xffff0000, v89
v_pk_fma_f32 v[36:37], v[50:51], v[28:29], v[36:37] op_sel_hi:[0,1,1]
v_pk_fma_f32 v[38:39], v[50:51], v[28:29], v[38:39] op_sel:[1,0,0] op_sel_hi:[1,1,1]
v_lshlrev_b32 v52, 16, v90
v_and_b32 v53, 0xffff0000, v90
v_pk_fma_f32 v[40:41], v[52:53], v[28:29], v[40:41] op_sel_hi:[0,1,1]
v_pk_fma_f32 v[42:43], v[52:53], v[28:29], v[42:43] op_sel:[1,0,0] op_sel_hi:[1,1,1]
v_lshlrev_b32 v54, 16, v91
v_and_b32 v55, 0xffff0000, v91
v_pk_fma_f32 v[44:45], v[54:55], v[28:29], v[44:45] op_sel_hi:[0,1,1]
v_pk_fma_f32 v[46:47], v[54:55], v[28:29], v[46:47] op_sel:[1,0,0] op_sel_hi:[1,1,1]
v_lshlrev_b32 v48, 16, v92
v_and_b32 v49, 0xffff0000, v92
v_pk_fma_f32 v[32:33], v[48:49], v[30:31], v[32:33] op_sel_hi:[0,1,1]
v_pk_fma_f32 v[34:35], v[48:49], v[30:31], v[34:35] op_sel:[1,0,0] op_sel_hi:[1,1,1]
v_lshlrev_b32 v50, 16, v93
v_and_b32 v51, 0xffff0000, v93
v_pk_fma_f32 v[36:37], v[50:51], v[30:31], v[36:37] op_sel_hi:[0,1,1]
v_pk_fma_f32 v[38:39], v[50:51], v[30:31], v[38:39] op_sel:[1,0,0] op_sel_hi:[1,1,1]
v_lshlrev_b32 v52, 16, v94
v_and_b32 v53, 0xffff0000, v94
v_pk_fma_f32 v[40:41], v[52:53], v[30:31], v[40:41] op_sel_hi:[0,1,1]
v_pk_fma_f32 v[42:43], v[52:53], v[30:31], v[42:43] op_sel:[1,0,0] op_sel_hi:[1,1,1]
v_lshlrev_b32 v54, 16, v95
v_and_b32 v55, 0xffff0000, v95
v_pk_fma_f32 v[44:45], v[54:55], v[30:31], v[44:45] op_sel_hi:[0,1,1]
v_pk_fma_f32 v[46:47], v[54:55], v[30:31], v[46:47] op_sel:[1,0,0] op_sel_hi:[1,1,1]
v_add_f32_dpp v32, v32, v32 row_ror:4 row_mask:0xf bank_mask:0xf
v_add_f32_dpp v33, v33, v33 row_ror:4 row_mask:0xf bank_mask:0xf
v_add_f32_dpp v34, v34, v34 row_ror:4 row_mask:0xf bank_mask:0xf
v_add_f32_dpp v35, v35, v35 row_ror:4 row_mask:0xf bank_mask:0xf
v_add_f32_dpp v36, v36, v36 row_ror:4 row_mask:0xf bank_mask:0xf
v_add_f32_dpp v37, v37, v37 row_ror:4 row_mask:0xf bank_mask:0xf
v_add_f32_dpp v38, v38, v38 row_ror:4 row_mask:0xf bank_mask:0xf
v_add_f32_dpp v39, v39, v39 row_ror:4 row_mask:0xf bank_mask:0xf
v_add_f32_dpp v40, v40, v40 row_ror:4 row_mask:0xf bank_mask:0xf
v_add_f32_dpp v41, v41, v41 row_ror:4 row_mask:0xf bank_mask:0xf
v_add_f32_dpp v42, v42, v42 row_ror:4 row_mask:0xf bank_mask:0xf
v_add_f32_dpp v43, v43, v43 row_ror:4 row_mask:0xf bank_mask:0xf
v_add_f32_dpp v44, v44, v44 row_ror:4 row_mask:0xf bank_mask:0xf
v_add_f32_dpp v45, v45, v45 row_ror:4 row_mask:0xf bank_mask:0xf
v_add_f32_dpp v46, v46, v46 row_ror:4 row_mask:0xf bank_mask:0xf
v_add_f32_dpp v47, v47, v47 row_ror:4 row_mask:0xf bank_mask:0xf
v_add_f32_dpp v32, v32, v32 row_ror:8 row_mask:0xf bank_mask:0xf
v_add_f32_dpp v33, v33, v33 row_ror:8 row_mask:0xf bank_mask:0xf
v_add_f32_dpp v34, v34, v34 row_ror:8 row_mask:0xf bank_mask:0xf
v_add_f32_dpp v35, v35, v35 row_ror:8 row_mask:0xf bank_mask:0xf
v_add_f32_dpp v36, v36, v36 row_ror:8 row_mask:0xf bank_mask:0xf
v_add_f32_dpp v37, v37, v37 row_ror:8 row_mask:0xf bank_mask:0xf
v_add_f32_dpp v38, v38, v38 row_ror:8 row_mask:0xf bank_mask:0xf
v_add_f32_dpp v39, v39, v39 row_ror:8 row_mask:0xf bank_mask:0xf
v_add_f32_dpp v40, v40, v40 row_ror:8 row_mask:0xf bank_mask:0xf
v_add_f32_dpp v41, v41, v41 row_ror:8 row_mask:0xf bank_mask:0xf
v_add_f32_dpp v42, v42, v42 row_ror:8 row_mask:0xf bank_mask:0xf
v_add_f32_dpp v43, v43, v43 row_ror:8 row_mask:0xf bank_mask:0xf
v_add_f32_dpp v44, v44, v44 row_ror:8 row_mask:0xf bank_mask:0xf
v_add_f32_dpp v45, v45, v45 row_ror:8 row_mask:0xf bank_mask:0xf
v_add_f32_dpp v46, v46, v46 row_ror:8 row_mask:0xf bank_mask:0xf
v_add_f32_dpp v47, v47, v47 row_ror:8 row_mask:0xf bank_mask:0xf
v_lshrrev_b32 v12, 4, v0
v_lshlrev_b32 v12, 8, v12
v_and_b32 v13, 3, v0
v_lshlrev_b32 v13, 6, v13
v_add_u32 v12, v12, v13
s_mov_b32 s16, 0x000f000f
s_mov_b32 s17, 0x000f000f
s_mov_b64 exec, s[16:17]
ds_write_b128 v12, v[32:35] offset:16384
ds_write_b128 v12, v[36:39] offset:16400
ds_write_b128 v12, v[40:43] offset:16416
ds_write_b128 v12, v[44:47] offset:16432
s_mov_b64 exec, -1
s_waitcnt lgkmcnt(0)
s_barrier
s_cmp_ge_u32 s24, 1
s_cbranch_scc1 K4_END
v_lshlrev_b32 v12, 2, v0
ds_read_b32 v16, v12 offset:16384
ds_read_b32 v17, v12 offset:16640
ds_read_b32 v18, v12 offset:16896
ds_read_b32 v19, v12 offset:17152
ds_read_b32 v20, v12 offset:17408
ds_read_b32 v21, v12 offset:17664
ds_read_b32 v22, v12 offset:17920
ds_read_b32 v23, v12 offset:18176
ds_read_b32 v24, v12 offset:18432
ds_read_b32 v25, v12 offset:18688
ds_read_b32 v26, v12 offset:18944
ds_read_b32 v27, v12 offset:19200
ds_read_b32 v28, v12 offset:19456
ds_read_b32 v29, v12 offset:19712
ds_read_b32 v30, v12 offset:19968
ds_read_b32 v31, v12 offset:20224
s_waitcnt lgkmcnt(0)
v_add_f32 v16, v16, v24
v_add_f32 v17, v17, v25
v_add_f32 v18, v18, v26
v_add_f32 v19, v19, v27
v_add_f32 v20, v20, v28
v_add_f32 v21, v21, v29
v_add_f32 v22, v22, v30
v_add_f32 v23, v23, v31
v_add_f32 v16, v16, v20
v_add_f32 v17, v17, v21
v_add_f32 v18, v18, v22
v_add_f32 v19, v19, v23
v_add_f32 v16, v16, v18
v_add_f32 v17, v17, v19
v_add_f32 v16, v16, v17
v_cvt_pk_bf16_f32 v16, v16, v16
v_lshlrev_b32 v16, 16, v16
v_mov_b32 v17, v16
s_nop 1
v_permlane32_swap_b32 v16, v17
s_mov_b32 s20, 0xbfb8aa3b
v_mul_f32 v19, s20, v16
v_exp_f32 v19, v19
s_nop 0
v_add_f32 v19, 1.0, v19
v_rcp_f32 v19, v19
s_nop 0
v_mul_f32 v18, v16, v19
v_cvt_pk_bf16_f32 v18, v18, v18
v_lshlrev_b32 v18, 16, v18
v_mul_f32 v18, v18, v17
v_cvt_pk_bf16_f32 v18, v18, v18
v_lshlrev_b32 v18, 16, v18
s_lshl_b32 s12, s2, 7
s_add_u32 s12, s12, 15294464
s_add_u32 s4, s4, s12
s_addc_u32 s5, s5, 0
s_mov_b32 exec_hi, 0
v_or_b32 v18, 1, v18
global_store_dword v12, v18, s[4:5] sc1
s_endpgm
K4_OUT:
s_load_dwordx2 s[6:7], s[0:1], 80
s_sub_u32 s12, s2, 86
v_and_b32 v1, 63, v0
v_lshrrev_b32 v2, 6, v0
s_lshl_b32 s13, s12, 4
v_add_u32 v2, s13, v2
v_lshlrev_b32 v3, 10, v2
v_lshlrev_b32 v4, 4, v1
v_add_u32 v3, v3, v4
v_add_u32 v7, 4096, v3
v_lshlrev_b32 v5, 2, v2
v_lshlrev_b32 v6, 5, v1
s_waitcnt lgkmcnt(0)
s_add_u32 s8, s4, 12582912
s_addc_u32 s9, s5, 0
s_add_u32 s14, s4, 15269888
s_addc_u32 s15, s5, 0
s_add_u32 s16, s4, 15278080
s_addc_u32 s17, s5, 0
s_add_u32 s20, s4, 15206400
s_addc_u32 s21, s5, 0
s_add_u32 s22, s4, 15210496
s_addc_u32 s23, s5, 0
s_mul_i32 s13, s12, 11008
s_add_u32 s13, s13, 20971520
s_add_u32 s24, s4, s13
s_addc_u32 s25, s5, 0
s_mov_b32 s26, 11008
s_mov_b32 s27, 0x00020000
v_lshlrev_b32 v10, 4, v0
v_add_u32 v8, 0x2000, v3
v_add_u32 v9, 0x3000, v3
global_load_dwordx4 v[16:19], v3, s[8:9]
global_load_dwordx4 v[20:23], v7, s[8:9]
global_load_dwordx4 v[24:27], v8, s[8:9]
global_load_dwordx4 v[28:31], v9, s[8:9]
global_load_dword v32, v5, s[14:15] offset:0
global_load_dword v36, v5, s[16:17] offset:0
global_load_dword v33, v5, s[14:15] offset:16
global_load_dword v37, v5, s[16:17] offset:16
global_load_dword v34, v5, s[14:15] offset:32
global_load_dword v38, v5, s[16:17] offset:32
global_load_dword v35, v5, s[14:15] offset:48
global_load_dword v39, v5, s[16:17] offset:48
global_load_dwordx4 v[40:43], v6, s[20:21]
global_load_dwordx4 v[44:47], v6, s[20:21] offset:16
global_load_dwordx4 v[48:51], v6, s[20:21] offset:2048
global_load_dwordx4 v[52:55], v6, s[20:21] offset:2064
global_load_dwordx4 v[56:59], v6, s[22:23]
global_load_dwordx4 v[60:63], v6, s[22:23] offset:16
v_bfe_u32 v11, v0, 1, 2
s_lshl_b32 s13, s12, 2
v_add_u32 v11, s13, v11
v_lshlrev_b32 v11, 2, v11
global_load_dword v116, v11, s[20:21]
global_load_dword v117, v11, s[20:21] offset:2048
global_load_dword v118, v11, s[22:23]
s_waitcnt vmcnt(3)
v_mul_f32 v84, 0x3b000000, v32
v_mul_f32 v85, v84, v84
v_mul_f32 v86, 0x3b000000, v36
v_sub_f32 v86, v86, v85
v_max_f32 v86, 0, v86
v_add_f32 v86, 0x3727c5ac, v86
v_rsq_f32 v86, v86
v_lshlrev_b32 v64, 16, v16
v_and_b32 v65, 0xffff0000, v16
v_lshlrev_b32 v66, 16, v17
v_and_b32 v67, 0xffff0000, v17
v_lshlrev_b32 v68, 16, v18
v_and_b32 v69, 0xffff0000, v18
v_lshlrev_b32 v70, 16, v19
v_and_b32 v71, 0xffff0000, v19
v_mov_b32 v72, v64
v_mov_b32 v73, v65
v_mov_b32 v74, v66
v_mov_b32 v75, v67
v_mov_b32 v76, v68
v_mov_b32 v77, v69
v_mov_b32 v78, v70
v_mov_b32 v79, v71
v_pk_add_f32 v[64:65], v[64:65], v[84:85] op_sel_hi:[1,0] neg_lo:[0,1] neg_hi:[0,1]
v_pk_add_f32 v[66:67], v[66:67], v[84:85] op_sel_hi:[1,0] neg_lo:[0,1] neg_hi:[0,1]
v_pk_add_f32 v[68:69], v[68:69], v[84:85] op_sel_hi:[1,0] neg_lo:[0,1] neg_hi:[0,1]
v_pk_add_f32 v[70:71], v[70:71], v[84:85] op_sel_hi:[1,0] neg_lo:[0,1] neg_hi:[0,1]
v_pk_mul_f32 v[64:65], v[64:65], v[86:87] op_sel_hi:[1,0]
v_pk_mul_f32 v[66:67], v[66:67], v[86:87] op_sel_hi:[1,0]
v_pk_mul_f32 v[68:69], v[68:69], v[86:87] op_sel_hi:[1,0]
v_pk_mul_f32 v[70:71], v[70:71], v[86:87] op_sel_hi:[1,0]
v_cvt_pk_bf16_f32 v80, v64, v65
v_cvt_pk_bf16_f32 v81, v66, v67
v_cvt_pk_bf16_f32 v82, v68, v69
v_cvt_pk_bf16_f32 v83, v70, v71
v_lshlrev_b32 v64, 16, v80
v_and_b32 v65, 0xffff0000, v80
v_lshlrev_b32 v66, 16, v81
v_and_b32 v67, 0xffff0000, v81
v_lshlrev_b32 v68, 16, v82
v_and_b32 v69, 0xffff0000, v82
v_lshlrev_b32 v70, 16, v83
v_and_b32 v71, 0xffff0000, v83
v_pk_mul_f32 v[64:65], v[64:65], v[48:49]
v_pk_mul_f32 v[66:67], v[66:67], v[50:51]
v_pk_mul_f32 v[68:69], v[68:69], v[52:53]
v_pk_mul_f32 v[70:71], v[70:71], v[54:55]
v_cvt_pk_bf16_f32 v80, v64, v65
v_cvt_pk_bf16_f32 v81, v66, v67
v_cvt_pk_bf16_f32 v82, v68, v69
v_cvt_pk_bf16_f32 v83, v70, v71
v_lshlrev_b32 v64, 16, v80
v_and_b32 v65, 0xffff0000, v80
v_lshlrev_b32 v66, 16, v81
v_and_b32 v67, 0xffff0000, v81
v_lshlrev_b32 v68, 16, v82
v_and_b32 v69, 0xffff0000, v82
v_lshlrev_b32 v70, 16, v83
v_and_b32 v71, 0xffff0000, v83
v_pk_add_f32 v[64:65], v[64:65], v[40:41]
v_pk_add_f32 v[66:67], v[66:67], v[42:43]
v_pk_add_f32 v[68:69], v[68:69], v[44:45]
v_pk_add_f32 v[70:71], v[70:71], v[46:47]
v_cvt_pk_bf16_f32 v80, v64, v65
v_cvt_pk_bf16_f32 v81, v66, v67
v_cvt_pk_bf16_f32 v82, v68, v69
v_cvt_pk_bf16_f32 v83, v70, v71
v_lshlrev_b32 v64, 16, v80
v_and_b32 v65, 0xffff0000, v80
v_lshlrev_b32 v66, 16, v81
v_and_b32 v67, 0xffff0000, v81
v_lshlrev_b32 v68, 16, v82
v_and_b32 v69, 0xffff0000, v82
v_lshlrev_b32 v70, 16, v83
v_and_b32 v71, 0xffff0000, v83
v_pk_mul_f32 v[64:65], v[64:65], v[56:57]
v_pk_mul_f32 v[66:67], v[66:67], v[58:59]
v_pk_mul_f32 v[68:69], v[68:69], v[60:61]
v_pk_mul_f32 v[70:71], v[70:71], v[62:63]
v_cvt_pk_bf16_f32 v80, v64, v65
v_cvt_pk_bf16_f32 v81, v66, v67
v_cvt_pk_bf16_f32 v82, v68, v69
v_cvt_pk_bf16_f32 v83, v70, v71
v_lshlrev_b32 v64, 16, v80
v_and_b32 v65, 0xffff0000, v80
v_lshlrev_b32 v66, 16, v81
v_and_b32 v67, 0xffff0000, v81
v_lshlrev_b32 v68, 16, v82
v_and_b32 v69, 0xffff0000, v82
v_lshlrev_b32 v70, 16, v83
v_and_b32 v71, 0xffff0000, v83
v_pk_add_f32 v[64:65], v[64:65], v[72:73]
v_pk_add_f32 v[66:67], v[66:67], v[74:75]
v_pk_add_f32 v[68:69], v[68:69], v[76:77]
v_pk_add_f32 v[70:71], v[70:71], v[78:79]
v_cvt_pk_bf16_f32 v88, v64, v65
v_cvt_pk_bf16_f32 v89, v66, v67
v_cvt_pk_bf16_f32 v90, v68, v69
v_cvt_pk_bf16_f32 v91, v70, v71
v_mul_f32 v84, 0x3b000000, v33
v_mul_f32 v85, v84, v84
v_mul_f32 v86, 0x3b000000, v37
v_sub_f32 v86, v86, v85
v_max_f32 v86, 0, v86
v_add_f32 v86, 0x3727c5ac, v86
v_rsq_f32 v86, v86
v_lshlrev_b32 v64, 16, v20
v_and_b32 v65, 0xffff0000, v20
v_lshlrev_b32 v66, 16, v21
v_and_b32 v67, 0xffff0000, v21
v_lshlrev_b32 v68, 16, v22
v_and_b32 v69, 0xffff0000, v22
v_lshlrev_b32 v70, 16, v23
v_and_b32 v71, 0xffff0000, v23
v_mov_b32 v72, v64
v_mov_b32 v73, v65
v_mov_b32 v74, v66
v_mov_b32 v75, v67
v_mov_b32 v76, v68
v_mov_b32 v77, v69
v_mov_b32 v78, v70
v_mov_b32 v79, v71
v_pk_add_f32 v[64:65], v[64:65], v[84:85] op_sel_hi:[1,0] neg_lo:[0,1] neg_hi:[0,1]
v_pk_add_f32 v[66:67], v[66:67], v[84:85] op_sel_hi:[1,0] neg_lo:[0,1] neg_hi:[0,1]
v_pk_add_f32 v[68:69], v[68:69], v[84:85] op_sel_hi:[1,0] neg_lo:[0,1] neg_hi:[0,1]
v_pk_add_f32 v[70:71], v[70:71], v[84:85] op_sel_hi:[1,0] neg_lo:[0,1] neg_hi:[0,1]
v_pk_mul_f32 v[64:65], v[64:65], v[86:87] op_sel_hi:[1,0]
v_pk_mul_f32 v[66:67], v[66:67], v[86:87] op_sel_hi:[1,0]
v_pk_mul_f32 v[68:69], v[68:69], v[86:87] op_sel_hi:[1,0]
v_pk_mul_f32 v[70:71], v[70:71], v[86:87] op_sel_hi:[1,0]
v_cvt_pk_bf16_f32 v80, v64, v65
v_cvt_pk_bf16_f32 v81, v66, v67
v_cvt_pk_bf16_f32 v82, v68, v69
v_cvt_pk_bf16_f32 v83, v70, v71
v_lshlrev_b32 v64, 16, v80
v_and_b32 v65, 0xffff0000, v80
v_lshlrev_b32 v66, 16, v81
v_and_b32 v67, 0xffff0000, v81
v_lshlrev_b32 v68, 16, v82
v_and_b32 v69, 0xffff0000, v82
v_lshlrev_b32 v70, 16, v83
v_and_b32 v71, 0xffff0000, v83
v_pk_mul_f32 v[64:65], v[64:65], v[48:49]
v_pk_mul_f32 v[66:67], v[66:67], v[50:51]
v_pk_mul_f32 v[68:69], v[68:69], v[52:53]
v_pk_mul_f32 v[70:71], v[70:71], v[54:55]
v_cvt_pk_bf16_f32 v80, v64, v65
v_cvt_pk_bf16_f32 v81, v66, v67
v_cvt_pk_bf16_f32 v82, v68, v69
v_cvt_pk_bf16_f32 v83, v70, v71
v_lshlrev_b32 v64, 16, v80
v_and_b32 v65, 0xffff0000, v80
v_lshlrev_b32 v66, 16, v81
v_and_b32 v67, 0xffff0000, v81
v_lshlrev_b32 v68, 16, v82
v_and_b32 v69, 0xffff0000, v82
v_lshlrev_b32 v70, 16, v83
v_and_b32 v71, 0xffff0000, v83
v_pk_add_f32 v[64:65], v[64:65], v[40:41]
v_pk_add_f32 v[66:67], v[66:67], v[42:43]
v_pk_add_f32 v[68:69], v[68:69], v[44:45]
v_pk_add_f32 v[70:71], v[70:71], v[46:47]
v_cvt_pk_bf16_f32 v80, v64, v65
v_cvt_pk_bf16_f32 v81, v66, v67
v_cvt_pk_bf16_f32 v82, v68, v69
v_cvt_pk_bf16_f32 v83, v70, v71
v_lshlrev_b32 v64, 16, v80
v_and_b32 v65, 0xffff0000, v80
v_lshlrev_b32 v66, 16, v81
v_and_b32 v67, 0xffff0000, v81
v_lshlrev_b32 v68, 16, v82
v_and_b32 v69, 0xffff0000, v82
v_lshlrev_b32 v70, 16, v83
v_and_b32 v71, 0xffff0000, v83
v_pk_mul_f32 v[64:65], v[64:65], v[56:57]
v_pk_mul_f32 v[66:67], v[66:67], v[58:59]
v_pk_mul_f32 v[68:69], v[68:69], v[60:61]
v_pk_mul_f32 v[70:71], v[70:71], v[62:63]
v_cvt_pk_bf16_f32 v80, v64, v65
v_cvt_pk_bf16_f32 v81, v66, v67
v_cvt_pk_bf16_f32 v82, v68, v69
v_cvt_pk_bf16_f32 v83, v70, v71
v_lshlrev_b32 v64, 16, v80
v_and_b32 v65, 0xffff0000, v80
v_lshlrev_b32 v66, 16, v81
v_and_b32 v67, 0xffff0000, v81
v_lshlrev_b32 v68, 16, v82
v_and_b32 v69, 0xffff0000, v82
v_lshlrev_b32 v70, 16, v83
v_and_b32 v71, 0xffff0000, v83
v_pk_add_f32 v[64:65], v[64:65], v[72:73]
v_pk_add_f32 v[66:67], v[66:67], v[74:75]
v_pk_add_f32 v[68:69], v[68:69], v[76:77]
v_pk_add_f32 v[70:71], v[70:71], v[78:79]
v_cvt_pk_bf16_f32 v92, v64, v65
v_cvt_pk_bf16_f32 v93, v66, v67
v_cvt_pk_bf16_f32 v94, v68, v69
v_cvt_pk_bf16_f32 v95, v70, v71
v_mul_f32 v84, 0x3b000000, v34
v_mul_f32 v85, v84, v84
v_mul_f32 v86, 0x3b000000, v38
v_sub_f32 v86, v86, v85
v_max_f32 v86, 0, v86
v_add_f32 v86, 0x3727c5ac, v86
v_rsq_f32 v86, v86
v_lshlrev_b32 v64, 16, v24
v_and_b32 v65, 0xffff0000, v24
v_lshlrev_b32 v66, 16, v25
v_and_b32 v67, 0xffff0000, v25
v_lshlrev_b32 v68, 16, v26
v_and_b32 v69, 0xffff0000, v26
v_lshlrev_b32 v70, 16, v27
v_and_b32 v71, 0xffff0000, v27
v_mov_b32 v72, v64
v_mov_b32 v73, v65
v_mov_b32 v74, v66
v_mov_b32 v75, v67
v_mov_b32 v76, v68
v_mov_b32 v77, v69
v_mov_b32 v78, v70
v_mov_b32 v79, v71
v_pk_add_f32 v[64:65], v[64:65], v[84:85] op_sel_hi:[1,0] neg_lo:[0,1] neg_hi:[0,1]
v_pk_add_f32 v[66:67], v[66:67], v[84:85] op_sel_hi:[1,0] neg_lo:[0,1] neg_hi:[0,1]
v_pk_add_f32 v[68:69], v[68:69], v[84:85] op_sel_hi:[1,0] neg_lo:[0,1] neg_hi:[0,1]
v_pk_add_f32 v[70:71], v[70:71], v[84:85] op_sel_hi:[1,0] neg_lo:[0,1] neg_hi:[0,1]
v_pk_mul_f32 v[64:65], v[64:65], v[86:87] op_sel_hi:[1,0]
v_pk_mul_f32 v[66:67], v[66:67], v[86:87] op_sel_hi:[1,0]
v_pk_mul_f32 v[68:69], v[68:69], v[86:87] op_sel_hi:[1,0]
v_pk_mul_f32 v[70:71], v[70:71], v[86:87] op_sel_hi:[1,0]
v_cvt_pk_bf16_f32 v80, v64, v65
v_cvt_pk_bf16_f32 v81, v66, v67
v_cvt_pk_bf16_f32 v82, v68, v69
v_cvt_pk_bf16_f32 v83, v70, v71
v_lshlrev_b32 v64, 16, v80
v_and_b32 v65, 0xffff0000, v80
v_lshlrev_b32 v66, 16, v81
v_and_b32 v67, 0xffff0000, v81
v_lshlrev_b32 v68, 16, v82
v_and_b32 v69, 0xffff0000, v82
v_lshlrev_b32 v70, 16, v83
v_and_b32 v71, 0xffff0000, v83
v_pk_mul_f32 v[64:65], v[64:65], v[48:49]
v_pk_mul_f32 v[66:67], v[66:67], v[50:51]
v_pk_mul_f32 v[68:69], v[68:69], v[52:53]
v_pk_mul_f32 v[70:71], v[70:71], v[54:55]
v_cvt_pk_bf16_f32 v80, v64, v65
v_cvt_pk_bf16_f32 v81, v66, v67
v_cvt_pk_bf16_f32 v82, v68, v69
v_cvt_pk_bf16_f32 v83, v70, v71
v_lshlrev_b32 v64, 16, v80
v_and_b32 v65, 0xffff0000, v80
v_lshlrev_b32 v66, 16, v81
v_and_b32 v67, 0xffff0000, v81
v_lshlrev_b32 v68, 16, v82
v_and_b32 v69, 0xffff0000, v82
v_lshlrev_b32 v70, 16, v83
v_and_b32 v71, 0xffff0000, v83
v_pk_add_f32 v[64:65], v[64:65], v[40:41]
v_pk_add_f32 v[66:67], v[66:67], v[42:43]
v_pk_add_f32 v[68:69], v[68:69], v[44:45]
v_pk_add_f32 v[70:71], v[70:71], v[46:47]
v_cvt_pk_bf16_f32 v80, v64, v65
v_cvt_pk_bf16_f32 v81, v66, v67
v_cvt_pk_bf16_f32 v82, v68, v69
v_cvt_pk_bf16_f32 v83, v70, v71
v_lshlrev_b32 v64, 16, v80
v_and_b32 v65, 0xffff0000, v80
v_lshlrev_b32 v66, 16, v81
v_and_b32 v67, 0xffff0000, v81
v_lshlrev_b32 v68, 16, v82
v_and_b32 v69, 0xffff0000, v82
v_lshlrev_b32 v70, 16, v83
v_and_b32 v71, 0xffff0000, v83
v_pk_mul_f32 v[64:65], v[64:65], v[56:57]
v_pk_mul_f32 v[66:67], v[66:67], v[58:59]
v_pk_mul_f32 v[68:69], v[68:69], v[60:61]
v_pk_mul_f32 v[70:71], v[70:71], v[62:63]
v_cvt_pk_bf16_f32 v80, v64, v65
v_cvt_pk_bf16_f32 v81, v66, v67
v_cvt_pk_bf16_f32 v82, v68, v69
v_cvt_pk_bf16_f32 v83, v70, v71
v_lshlrev_b32 v64, 16, v80
v_and_b32 v65, 0xffff0000, v80
v_lshlrev_b32 v66, 16, v81
v_and_b32 v67, 0xffff0000, v81
v_lshlrev_b32 v68, 16, v82
v_and_b32 v69, 0xffff0000, v82
v_lshlrev_b32 v70, 16, v83
v_and_b32 v71, 0xffff0000, v83
v_pk_add_f32 v[64:65], v[64:65], v[72:73]
v_pk_add_f32 v[66:67], v[66:67], v[74:75]
v_pk_add_f32 v[68:69], v[68:69], v[76:77]
v_pk_add_f32 v[70:71], v[70:71], v[78:79]
v_cvt_pk_bf16_f32 v96, v64, v65
v_cvt_pk_bf16_f32 v97, v66, v67
v_cvt_pk_bf16_f32 v98, v68, v69
v_cvt_pk_bf16_f32 v99, v70, v71
v_mul_f32 v84, 0x3b000000, v35
v_mul_f32 v85, v84, v84
v_mul_f32 v86, 0x3b000000, v39
v_sub_f32 v86, v86, v85
v_max_f32 v86, 0, v86
v_add_f32 v86, 0x3727c5ac, v86
v_rsq_f32 v86, v86
v_lshlrev_b32 v64, 16, v28
v_and_b32 v65, 0xffff0000, v28
v_lshlrev_b32 v66, 16, v29
v_and_b32 v67, 0xffff0000, v29
v_lshlrev_b32 v68, 16, v30
v_and_b32 v69, 0xffff0000, v30
v_lshlrev_b32 v70, 16, v31
v_and_b32 v71, 0xffff0000, v31
v_mov_b32 v72, v64
v_mov_b32 v73, v65
v_mov_b32 v74, v66
v_mov_b32 v75, v67
v_mov_b32 v76, v68
v_mov_b32 v77, v69
v_mov_b32 v78, v70
v_mov_b32 v79, v71
v_pk_add_f32 v[64:65], v[64:65], v[84:85] op_sel_hi:[1,0] neg_lo:[0,1] neg_hi:[0,1]
v_pk_add_f32 v[66:67], v[66:67], v[84:85] op_sel_hi:[1,0] neg_lo:[0,1] neg_hi:[0,1]
v_pk_add_f32 v[68:69], v[68:69], v[84:85] op_sel_hi:[1,0] neg_lo:[0,1] neg_hi:[0,1]
v_pk_add_f32 v[70:71], v[70:71], v[84:85] op_sel_hi:[1,0] neg_lo:[0,1] neg_hi:[0,1]
v_pk_mul_f32 v[64:65], v[64:65], v[86:87] op_sel_hi:[1,0]
v_pk_mul_f32 v[66:67], v[66:67], v[86:87] op_sel_hi:[1,0]
v_pk_mul_f32 v[68:69], v[68:69], v[86:87] op_sel_hi:[1,0]
v_pk_mul_f32 v[70:71], v[70:71], v[86:87] op_sel_hi:[1,0]
v_cvt_pk_bf16_f32 v80, v64, v65
v_cvt_pk_bf16_f32 v81, v66, v67
v_cvt_pk_bf16_f32 v82, v68, v69
v_cvt_pk_bf16_f32 v83, v70, v71
v_lshlrev_b32 v64, 16, v80
v_and_b32 v65, 0xffff0000, v80
v_lshlrev_b32 v66, 16, v81
v_and_b32 v67, 0xffff0000, v81
v_lshlrev_b32 v68, 16, v82
v_and_b32 v69, 0xffff0000, v82
v_lshlrev_b32 v70, 16, v83
v_and_b32 v71, 0xffff0000, v83
v_pk_mul_f32 v[64:65], v[64:65], v[48:49]
v_pk_mul_f32 v[66:67], v[66:67], v[50:51]
v_pk_mul_f32 v[68:69], v[68:69], v[52:53]
v_pk_mul_f32 v[70:71], v[70:71], v[54:55]
v_cvt_pk_bf16_f32 v80, v64, v65
v_cvt_pk_bf16_f32 v81, v66, v67
v_cvt_pk_bf16_f32 v82, v68, v69
v_cvt_pk_bf16_f32 v83, v70, v71
v_lshlrev_b32 v64, 16, v80
v_and_b32 v65, 0xffff0000, v80
v_lshlrev_b32 v66, 16, v81
v_and_b32 v67, 0xffff0000, v81
v_lshlrev_b32 v68, 16, v82
v_and_b32 v69, 0xffff0000, v82
v_lshlrev_b32 v70, 16, v83
v_and_b32 v71, 0xffff0000, v83
v_pk_add_f32 v[64:65], v[64:65], v[40:41]
v_pk_add_f32 v[66:67], v[66:67], v[42:43]
v_pk_add_f32 v[68:69], v[68:69], v[44:45]
v_pk_add_f32 v[70:71], v[70:71], v[46:47]
v_cvt_pk_bf16_f32 v80, v64, v65
v_cvt_pk_bf16_f32 v81, v66, v67
v_cvt_pk_bf16_f32 v82, v68, v69
v_cvt_pk_bf16_f32 v83, v70, v71
v_lshlrev_b32 v64, 16, v80
v_and_b32 v65, 0xffff0000, v80
v_lshlrev_b32 v66, 16, v81
v_and_b32 v67, 0xffff0000, v81
v_lshlrev_b32 v68, 16, v82
v_and_b32 v69, 0xffff0000, v82
v_lshlrev_b32 v70, 16, v83
v_and_b32 v71, 0xffff0000, v83
v_pk_mul_f32 v[64:65], v[64:65], v[56:57]
v_pk_mul_f32 v[66:67], v[66:67], v[58:59]
v_pk_mul_f32 v[68:69], v[68:69], v[60:61]
v_pk_mul_f32 v[70:71], v[70:71], v[62:63]
v_cvt_pk_bf16_f32 v80, v64, v65
v_cvt_pk_bf16_f32 v81, v66, v67
v_cvt_pk_bf16_f32 v82, v68, v69
v_cvt_pk_bf16_f32 v83, v70, v71
v_lshlrev_b32 v64, 16, v80
v_and_b32 v65, 0xffff0000, v80
v_lshlrev_b32 v66, 16, v81
v_and_b32 v67, 0xffff0000, v81
v_lshlrev_b32 v68, 16, v82
v_and_b32 v69, 0xffff0000, v82
v_lshlrev_b32 v70, 16, v83
v_and_b32 v71, 0xffff0000, v83
v_pk_add_f32 v[64:65], v[64:65], v[72:73]
v_pk_add_f32 v[66:67], v[66:67], v[74:75]
v_pk_add_f32 v[68:69], v[68:69], v[76:77]
v_pk_add_f32 v[70:71], v[70:71], v[78:79]
v_cvt_pk_bf16_f32 v100, v64, v65
v_cvt_pk_bf16_f32 v101, v66, v67
v_cvt_pk_bf16_f32 v102, v68, v69
v_cvt_pk_bf16_f32 v103, v70, v71
buffer_load_dwordx4 v[104:107], v10, s[24:27], 0 offen offset:0
v_add_u32 v10, 4096, v10
buffer_load_dwordx4 v[108:111], v10, s[24:27], 0 offen
v_add_u32 v10, 4096, v10
buffer_load_dwordx4 v[112:115], v10, s[24:27], 0 offen
v_add_u32 v10, 4096, v10
s_add_u32 s28, s4, 15305728
s_addc_u32 s29, s5, 0
s_and_b32 s30, s12, 31
s_lshl_b32 s30, s30, 7
v_mov_b32 v12, s30
K4_PS:
global_load_dwordx4 v[120:123], v12, s[28:29] sc1
s_waitcnt vmcnt(0)
v_min_u32 v13, v120, v121
v_min3_u32 v13, v13, v122, v123
s_nop 0
v_readfirstlane_b32 s30, v13
s_nop 3
s_cmp_eq_u32 s30, 0
s_cbranch_scc1 K4_PS
v_readfirstlane_b32 s30, v120
v_readfirstlane_b32 s31, v122
s_nop 2
s_sub_u32 s30, s30, 1
s_nop 2
s_sub_u32 s31, s31, 1
v_and_b32 v13, 1, v0
v_cmp_eq_u32 vcc, 0, v13
v_mov_b32 v14, s31
v_mov_b32 v15, s30
v_cndmask_b32 v14, v14, v15, vcc
v_cndmask_b32 v119, v123, v121, vcc
v_and_b32 v119, 0xffff0000, v119
v_lshlrev_b32 v15, 10, v14
v_lshrrev_b32 v11, 1, v11
v_add_u32 v11, v15, v11
v_lshlrev_b32 v14, 2, v14
global_load_ushort v124, v11, s[8:9]
global_load_dword v125, v14, s[14:15]
global_load_dword v126, v14, s[16:17]
v_readfirstlane_b32 s33, v2
s_nop 3
s_cmp_eq_u32 s33, s30
s_cbranch_scc1 K4_SK0
s_nop 1
s_cmp_eq_u32 s33, s31
s_cbranch_scc1 K4_SK0
global_store_dwordx4 v3, v[88:91], s[6:7]
K4_SK0:
s_nop 1
s_add_u32 s33, s33, 4
s_nop 0
s_cmp_eq_u32 s33, s30
s_cbranch_scc1 K4_SK1
s_cmp_eq_u32 s33, s31
s_cbranch_scc1 K4_SK1
global_store_dwordx4 v7, v[92:95], s[6:7]
K4_SK1:
s_add_u32 s33, s33, 4
s_cmp_eq_u32 s33, s30
s_cbranch_scc1 K4_SK2
s_cmp_eq_u32 s33, s31
s_cbranch_scc1 K4_SK2
global_store_dwordx4 v8, v[96:99], s[6:7]
K4_SK2:
s_add_u32 s33, s33, 4
s_cmp_eq_u32 s33, s30
s_cbranch_scc1 K4_SK3
s_cmp_eq_u32 s33, s31
s_cbranch_scc1 K4_SK3
global_store_dwordx4 v9, v[100:103], s[6:7]
K4_SK3:
s_add_u32 s34, s4, 15294464
s_addc_u32 s35, s5, 0
v_lshlrev_b32 v12, 4, v0
v_add_u32 v13, 4096, v12
v_add_u32 v14, 8192, v12
v_min_u32 v14, 10992, v14
v_readfirstlane_b32 s38, v0
s_nop 3
s_lshr_b32 s38, s38, 6
s_lshl_b32 s39, s12, 2
s_nop 1
s_add_u32 s38, s38, s39
s_nop 0
s_mul_i32 s39, s38, 763
s_lshr_b32 s39, s39, 16
s_mul_i32 s39, s39, 86
s_sub_u32 s38, s38, s39
s_lshl_b32 s38, s38, 7
v_mov_b32 v15, s38
K4_P1:
global_load_dword v28, v15, s[34:35] sc1
s_waitcnt vmcnt(0)
v_readfirstlane_b32 s38, v28
s_nop 3
s_cmp_eq_u32 s38, 0
s_cbranch_scc1 K4_P1
K4_PA:
global_load_dwordx4 v[16:19], v12, s[34:35] sc1
global_load_dwordx4 v[20:23], v13, s[34:35] sc1
global_load_dwordx4 v[24:27], v14, s[34:35] sc1
s_waitcnt vmcnt(0)
v_and_b32 v15, v16, v17
v_and_b32 v28, v18, v19
v_and_b32 v15, v15, v28
v_and_b32 v28, v20, v21
v_and_b32 v15, v15, v28
v_and_b32 v28, v22, v23
v_and_b32 v15, v15, v28
v_and_b32 v28, v24, v25
v_and_b32 v15, v15, v28
v_and_b32 v28, v26, v27
v_and_b32 v15, v15, v28
v_and_b32 v15, 1, v15
v_cmp_eq_u32 vcc, 0, v15
s_cbranch_vccnz K4_PA
v_lshlrev_b32 v40, 16, v104
v_and_b32 v41, 0xffff0000, v104
v_lshlrev_b32 v42, 16, v105
v_and_b32 v43, 0xffff0000, v105
v_lshlrev_b32 v44, 16, v106
v_and_b32 v45, 0xffff0000, v106
v_lshlrev_b32 v46, 16, v107
v_and_b32 v47, 0xffff0000, v107
v_pk_mul_f32 v[32:33], v[40:41], v[16:17] op_sel_hi:[0,1]
v_pk_mul_f32 v[34:35], v[40:41], v[16:17] op_sel:[1,0] op_sel_hi:[1,1]
v_pk_mul_f32 v[36:37], v[42:43], v[16:17] op_sel_hi:[0,1]
v_pk_mul_f32 v[38:39], v[42:43], v[16:17] op_sel:[1,0] op_sel_hi:[1,1]
v_pk_fma_f32 v[32:33], v[44:45], v[18:19], v[32:33] op_sel_hi:[0,1,1]
v_pk_fma_f32 v[34:35], v[44:45], v[18:19], v[34:35] op_sel:[1,0,0] op_sel_hi:[1,1,1]
v_pk_fma_f32 v[36:37], v[46:47], v[18:19], v[36:37] op_sel_hi:[0,1,1]
v_pk_fma_f32 v[38:39], v[46:47], v[18:19], v[38:39] op_sel:[1,0,0] op_sel_hi:[1,1,1]
v_lshlrev_b32 v40, 16, v108
v_and_b32 v41, 0xffff0000, v108
v_lshlrev_b32 v42, 16, v109
v_and_b32 v43, 0xffff0000, v109
v_lshlrev_b32 v44, 16, v110
v_and_b32 v45, 0xffff0000, v110
v_lshlrev_b32 v46, 16, v111
v_and_b32 v47, 0xffff0000, v111
v_pk_fma_f32 v[32:33], v[40:41], v[20:21], v[32:33] op_sel_hi:[0,1,1]
v_pk_fma_f32 v[34:35], v[40:41], v[20:21], v[34:35] op_sel:[1,0,0] op_sel_hi:[1,1,1]
v_pk_fma_f32 v[36:37], v[42:43], v[20:21], v[36:37] op_sel_hi:[0,1,1]
v_pk_fma_f32 v[38:39], v[42:43], v[20:21], v[38:39] op_sel:[1,0,0] op_sel_hi:[1,1,1]
v_pk_fma_f32 v[32:33], v[44:45], v[22:23], v[32:33] op_sel_hi:[0,1,1]
v_pk_fma_f32 v[34:35], v[44:45], v[22:23], v[34:35] op_sel:[1,0,0] op_sel_hi:[1,1,1]
v_pk_fma_f32 v[36:37], v[46:47], v[22:23], v[36:37] op_sel_hi:[0,1,1]
v_pk_fma_f32 v[38:39], v[46:47], v[22:23], v[38:39] op_sel:[1,0,0] op_sel_hi:[1,1,1]
v_lshlrev_b32 v40, 16, v112
v_and_b32 v41, 0xffff0000, v112
v_lshlrev_b32 v42, 16, v113
v_and_b32 v43, 0xffff0000, v113
v_lshlrev_b32 v44, 16, v114
v_and_b32 v45, 0xffff0000, v114
v_lshlrev_b32 v46, 16, v115
v_and_b32 v47, 0xffff0000, v115
v_pk_fma_f32 v[32:33], v[40:41], v[24:25], v[32:33] op_sel_hi:[0,1,1]
v_pk_fma_f32 v[34:35], v[40:41], v[24:25], v[34:35] op_sel:[1,0,0] op_sel_hi:[1,1,1]
v_pk_fma_f32 v[36:37], v[42:43], v[24:25], v[36:37] op_sel_hi:[0,1,1]
v_pk_fma_f32 v[38:39], v[42:43], v[24:25], v[38:39] op_sel:[1,0,0] op_sel_hi:[1,1,1]
v_pk_fma_f32 v[32:33], v[44:45], v[26:27], v[32:33] op_sel_hi:[0,1,1]
v_pk_fma_f32 v[34:35], v[44:45], v[26:27], v[34:35] op_sel:[1,0,0] op_sel_hi:[1,1,1]
v_pk_fma_f32 v[36:37], v[46:47], v[26:27], v[36:37] op_sel_hi:[0,1,1]
v_pk_fma_f32 v[38:39], v[46:47], v[26:27], v[38:39] op_sel:[1,0,0] op_sel_hi:[1,1,1]
v_add_f32_dpp v32, v32, v32 quad_perm:[1,0,3,2] row_mask:0xf bank_mask:0xf
v_add_f32_dpp v33, v33, v33 quad_perm:[1,0,3,2] row_mask:0xf bank_mask:0xf
v_add_f32_dpp v34, v34, v34 quad_perm:[1,0,3,2] row_mask:0xf bank_mask:0xf
v_add_f32_dpp v35, v35, v35 quad_perm:[1,0,3,2] row_mask:0xf bank_mask:0xf
v_add_f32_dpp v36, v36, v36 quad_perm:[1,0,3,2] row_mask:0xf bank_mask:0xf
v_add_f32_dpp v37, v37, v37 quad_perm:[1,0,3,2] row_mask:0xf bank_mask:0xf
v_add_f32_dpp v38, v38, v38 quad_perm:[1,0,3,2] row_mask:0xf bank_mask:0xf
v_add_f32_dpp v39, v39, v39 quad_perm:[1,0,3,2] row_mask:0xf bank_mask:0xf
v_add_f32_dpp v32, v32, v32 quad_perm:[2,3,0,1] row_mask:0xf bank_mask:0xf
v_add_f32_dpp v33, v33, v33 quad_perm:[2,3,0,1] row_mask:0xf bank_mask:0xf
v_add_f32_dpp v34, v34, v34 quad_perm:[2,3,0,1] row_mask:0xf bank_mask:0xf
v_add_f32_dpp v35, v35, v35 quad_perm:[2,3,0,1] row_mask:0xf bank_mask:0xf
v_add_f32_dpp v36, v36, v36 quad_perm:[2,3,0,1] row_mask:0xf bank_mask:0xf
v_add_f32_dpp v37, v37, v37 quad_perm:[2,3,0,1] row_mask:0xf bank_mask:0xf
v_add_f32_dpp v38, v38, v38 quad_perm:[2,3,0,1] row_mask:0xf bank_mask:0xf
v_add_f32_dpp v39, v39, v39 quad_perm:[2,3,0,1] row_mask:0xf bank_mask:0xf
v_add_f32_dpp v32, v32, v32 row_half_mirror row_mask:0xf bank_mask:0xf
v_add_f32_dpp v33, v33, v33 row_half_mirror row_mask:0xf bank_mask:0xf
v_add_f32_dpp v34, v34, v34 row_half_mirror row_mask:0xf bank_mask:0xf
v_add_f32_dpp v35, v35, v35 row_half_mirror row_mask:0xf bank_mask:0xf
v_add_f32_dpp v36, v36, v36 row_half_mirror row_mask:0xf bank_mask:0xf
v_add_f32_dpp v37, v37, v37 row_half_mirror row_mask:0xf bank_mask:0xf
v_add_f32_dpp v38, v38, v38 row_half_mirror row_mask:0xf bank_mask:0xf
v_add_f32_dpp v39, v39, v39 row_half_mirror row_mask:0xf bank_mask:0xf
v_add_f32_dpp v32, v32, v32 row_mirror row_mask:0xf bank_mask:0xf
v_add_f32_dpp v33, v33, v33 row_mirror row_mask:0xf bank_mask:0xf
v_add_f32_dpp v34, v34, v34 row_mirror row_mask:0xf bank_mask:0xf
v_add_f32_dpp v35, v35, v35 row_mirror row_mask:0xf bank_mask:0xf
v_add_f32_dpp v36, v36, v36 row_mirror row_mask:0xf bank_mask:0xf
v_add_f32_dpp v37, v37, v37 row_mirror row_mask:0xf bank_mask:0xf
v_add_f32_dpp v38, v38, v38 row_mirror row_mask:0xf bank_mask:0xf
v_add_f32_dpp v39, v39, v39 row_mirror row_mask:0xf bank_mask:0xf
v_lshrrev_b32 v12, 4, v0
v_lshlrev_b32 v12, 5, v12
s_mov_b32 s36, 0x00010001
s_mov_b32 s37, 0x00010001
s_mov_b64 exec, s[36:37]
ds_write_b128 v12, v[32:35]
ds_write_b128 v12, v[36:39] offset:16
s_mov_b64 exec, -1
v_mul_f32 v44, 0x3b000000, v125
v_mul_f32 v45, v44, v44
v_mul_f32 v46, 0x3b000000, v126
v_sub_f32 v46, v46, v45
v_max_f32 v46, 0, v46
v_add_f32 v46, 0x3727c5ac, v46
v_rsq_f32 v46, v46
v_lshlrev_b32 v124, 16, v124
v_sub_f32 v47, v124, v44
v_mul_f32 v47, v47, v46
v_cvt_pk_bf16_f32 v47, v47, v47
v_lshlrev_b32 v47, 16, v47
v_mul_f32 v47, v47, v117
v_cvt_pk_bf16_f32 v47, v47, v47
v_lshlrev_b32 v47, 16, v47
v_add_f32 v47, v47, v116
v_cvt_pk_bf16_f32 v47, v47, v47
v_lshlrev_b32 v47, 16, v47
s_waitcnt lgkmcnt(0)
s_barrier
v_readfirstlane_b32 s14, v0
s_nop 3
s_cmp_ge_u32 s14, 64
s_cbranch_scc1 K4_END
v_lshlrev_b32 v12, 2, v0
ds_read_b32 v16, v12
ds_read_b32 v17, v12 offset:256
s_waitcnt lgkmcnt(0)
v_add_f32 v16, v16, v17
s_nop 1
v_add_f32_dpp v16, v16, v16 row_ror:8 row_mask:0xf bank_mask:0xf
v_mov_b32 v17, v16
s_nop 1
v_permlane16_swap_b32 v16, v17
v_add_f32 v16, v16, v17
v_mov_b32 v17, v16
s_nop 1
v_permlane32_swap_b32 v16, v17
v_add_f32 v16, v16, v17
v_cvt_pk_bf16_f32 v16, v16, v16
v_lshlrev_b32 v16, 16, v16
v_mul_f32 v16, v16, v119
v_cvt_pk_bf16_f32 v16, v16, v16
v_lshlrev_b32 v16, 16, v16
v_add_f32 v16, v16, v47
v_cvt_pk_bf16_f32 v16, v16, v16
v_lshlrev_b32 v16, 16, v16
v_mul_f32 v16, v16, v118
v_cvt_pk_bf16_f32 v16, v16, v16
v_lshlrev_b32 v16, 16, v16
v_add_f32 v16, v16, v124
v_cvt_pk_bf16_f32 v16, v16, v16
s_mov_b64 exec, 0xff
global_store_short v11, v16, s[6:7]
K4_END:
s_endpgm
.section .rodata,"a"
.p2align 6
.amdhsa_kernel k0_kernel
  .amdhsa_next_free_vgpr 160
  .amdhsa_next_free_sgpr 102
  .amdhsa_accum_offset 160
  .amdhsa_group_segment_fixed_size 0
  .amdhsa_kernarg_size 104
  .amdhsa_user_sgpr_count 2
  .amdhsa_user_sgpr_kernarg_segment_ptr 1
  .amdhsa_system_sgpr_workgroup_id_x 1
.end_amdhsa_kernel
.p2align 6
.amdhsa_kernel k1_kernel
  .amdhsa_next_free_vgpr 512
  .amdhsa_next_free_sgpr 102
  .amdhsa_accum_offset 256
  .amdhsa_group_segment_fixed_size 0
  .amdhsa_kernarg_size 104
  .amdhsa_user_sgpr_count 2
  .amdhsa_user_sgpr_kernarg_segment_ptr 1
  .amdhsa_system_sgpr_workgroup_id_x 1
.end_amdhsa_kernel
.p2align 6
.amdhsa_kernel k2_kernel
  .amdhsa_next_free_vgpr 256
  .amdhsa_next_free_sgpr 102
  .amdhsa_accum_offset 256
  .amdhsa_group_segment_fixed_size 0
  .amdhsa_kernarg_size 104
  .amdhsa_user_sgpr_count 2
  .amdhsa_user_sgpr_kernarg_segment_ptr 1
  .amdhsa_system_sgpr_workgroup_id_x 1
.end_amdhsa_kernel
.p2align 6
.amdhsa_kernel k4_kernel
  .amdhsa_next_free_vgpr 128
  .amdhsa_next_free_sgpr 102
  .amdhsa_accum_offset 128
  .amdhsa_group_segment_fixed_size 0
  .amdhsa_kernarg_size 104
  .amdhsa_user_sgpr_count 2
  .amdhsa_user_sgpr_kernarg_segment_ptr 1
  .amdhsa_system_sgpr_workgroup_id_x 1
.end_amdhsa_kernel
```
